```python
import torch

def _softmax(x, axis=-1):
    return torch.softmax(x, dim=axis)
def _gelu(x):
    return torch.nn.functional.gelu(x, approximate="tanh")
def _silu(x):
    return torch.nn.functional.silu(x)
def _sigmoid(x):
    return torch.sigmoid(x)
def _layernorm(x, axis=-1, eps=1e-5):
    m = x.mean(dim=axis, keepdim=True)
    v = x.var(dim=axis, keepdim=True, unbiased=False)
    return (x - m) / torch.sqrt(v + eps)
def _scatter_add(tgt, idx, src, axis=0):
    return tgt.clone().index_add_(axis, idx, src)
def _segment_sum(src, seg, n):
    out = torch.zeros((n,) + src.shape[1:], dtype=src.dtype)
    return out.index_add_(0, seg, src)
def _pad(x, pw):
    flat = tuple(v for pair in reversed(pw) for v in pair)
    return torch.nn.functional.pad(x, flat)

kernel_name = 'standalone__dense_activation_gelu__prompt'

def setup_inputs():

    _w = (lambda a: (lambda t: t.to(torch.bfloat16) if t.is_floating_point() else t)(torch.as_tensor(a)))
    B, S, D, F = 1, 2048, 640, 1536
    return {
        "x": _w((lambda *s: torch.randn(*s, dtype=torch.bfloat16) * 0.05)(B, S, D)),
        "w1": _w((lambda *s: torch.randn(*s, dtype=torch.bfloat16) * 3.2)(D, F) * (D ** -0.5)),
        "b1": _w((lambda *s: torch.randn(*s, dtype=torch.bfloat16) * 3.2)(F) * 0.01),
        "w2": _w((lambda *s: torch.randn(*s, dtype=torch.bfloat16) * 0.05)(F, D) * (F ** -0.5)),
        "b2": _w((lambda *s: torch.randn(*s, dtype=torch.bfloat16) * 0.1)(D) * 0.01),
    }

def reference(x, w1, b1, w2, b2):
    h = torch.einsum("bsd,df->bsf", x, w1) + b1
    h = _gelu(h)
    return torch.einsum("bsf,fd->bsd", h, w2) + b2
```

```asm
; @launch grid=(256,1,1) block=(384,1,1) lds=163840
.amdgcn_target "amdgcn-amd-amdhsa--gfx950"
.text
.globl standalone__dense_activation_gelu__prompt_kernel
.p2align 8
.type standalone__dense_activation_gelu__prompt_kernel,@function
standalone__dense_activation_gelu__prompt_kernel:
s_load_dwordx2 s[20:21], s[0:1], 0
s_load_dwordx2 s[24:25], s[0:1], 8
s_cmpk_ge_u32 s2, 0x100
s_cbranch_scc1 L_end
s_getpc_b64 s[64:65]
L_pf0:
v_readfirstlane_b32 s50, v0
s_lshr_b32 s53, s2, 3
s_mul_i32 s59, s53, 960
v_mad_u32_u24 v30, v0, 3, s59
global_load_ubyte v92, v30, s[64:65]
s_lshr_b32 s50, s50, 6
s_and_b32 s54, s53, 7
s_lshr_b32 s55, s53, 3
s_bfe_u32 s47, s2, 0x20001
s_lshl3_add_u32 s48, s47, s54
s_and_b32 s46, s2, 1
s_lshl2_add_u32 s49, s46, s55
s_cmp_ge_u32 s50, 4
s_cbranch_scc1 L_loader
s_lshl2_add_u32 s5, s53, s47
s_mulk_i32 s5, 10
s_add_u32 s5, s5, s46
v_mul_u32_u24 v29, 5, v0
v_lshrrev_b32 v29, 8, v29
v_add_u32 v29, s5, v29
v_mul_u32_u24 v29, 0x600, v29
v_mad_u32_u24 v29, v0, 30, v29
s_and_b32 s4, s2, 7
s_lshl_b32 s4, s4, 5
s_add_u32 s4, s4, s53
s_mulk_i32 s4, 10240
v_mad_u32_u24 v30, v0, 40, s4
v_and_b32 v0, 63, v0
s_waitcnt lgkmcnt(0)
global_load_dword v93, v30, s[20:21]
global_load_ubyte v94, v29, s[24:25]
s_branch L_compute
L_loader:
s_load_dwordx2 s[28:29], s[0:1], 24
s_load_dwordx2 s[32:33], s[0:1], 56
v_and_b32 v0, 63, v0
s_sub_u32 s56, s50, 4
s_mov_b32 s22, 2621440
s_mov_b32 s23, 0x20000
s_mov_b32 s26, 1966080
s_mov_b32 s27, 0x20000
s_mul_i32 s63, s48, 81920
s_lshl_b32 s57, s56, 10
v_lshrrev_b32 v1, 3, v0
s_lshl_b32 s60, s56, 3
v_add_u32 v1, s60, v1
v_and_b32 v5, 7, v0
v_bfe_u32 v6, v1, 1, 3
v_xor_b32 v6, v5, v6
v_mul_u32_u24 v2, 1280, v1
v_lshl_add_u32 v2, v6, 4, v2
v_lshrrev_b32 v6, 1, v1
v_and_b32 v6, 4, v6
v_and_or_b32 v6, v1, 2, v6
v_xor_b32 v6, v5, v6
v_mul_u32_u24 v3, 3072, v1
v_lshl_add_u32 v3, v6, 4, v3
s_mul_i32 s64, s49, 384
s_waitcnt lgkmcnt(0)
s_add_u32 m0, s57, 0
s_add_u32 s69, s63, 0
buffer_load_dwordx4 v2, s[20:23], s69 offen  lds
s_add_u32 m0, s57, 2048
s_add_u32 s69, s69, 20480
buffer_load_dwordx4 v2, s[20:23], s69 offen  lds
s_add_u32 m0, s57, 4096
s_add_u32 s69, s69, 20480
buffer_load_dwordx4 v2, s[20:23], s69 offen  lds
s_add_u32 m0, s57, 6144
s_add_u32 s69, s69, 20480
buffer_load_dwordx4 v2, s[20:23], s69 offen  lds
s_add_u32 m0, s57, 8192
s_add_u32 s69, s64, 0
buffer_load_dwordx4 v3, s[24:27], s69 offen  lds
s_add_u32 m0, s57, 10240
s_add_u32 s69, s69, 49152
buffer_load_dwordx4 v3, s[24:27], s69 offen  lds
s_add_u32 m0, s57, 12288
s_add_u32 s69, s69, 49152
buffer_load_dwordx4 v3, s[24:27], s69 offen  lds
s_add_u32 m0, s57, 14336
s_add_u32 s69, s69, 49152
buffer_load_dwordx4 v3, s[24:27], s69 offen  lds
s_mov_b32 s30, 1966080
s_mov_b32 s31, 0x20000
s_lshr_b32 s67, s2, 2
s_lshl_b32 s67, s67, 5
s_and_b32 s68, s2, 3
s_lshl_b32 s68, s68, 2
s_add_u32 s67, s67, s68
s_mul_i32 s67, s67, 1280
s_lshl_b32 s68, s56, 7
s_add_u32 s65, s67, s68
v_lshrrev_b32 v21, 5, v0
v_mul_u32_u24 v21, 12, v21
v_lshrrev_b32 v23, 3, v0
v_add_u32 v23, v23, v21
v_mul_u32_u24 v23, 1280, v23
v_lshl_add_u32 v23, v5, 4, v23
v_add_u32 v23, 0x400, v23
v_lshrrev_b32 v22, 2, v0
v_mul_u32_u24 v22, 1280, v22
v_and_b32 v21, 3, v0
v_cmp_gt_u32 vcc, 24, v0
v_lshl_add_u32 v22, v21, 7, v22
v_mov_b32 v21, 0x7fffff00
v_cndmask_b32 v22, v21, v22, vcc
s_lshl_b32 s67, s47, 5
s_add_u32 s67, s67, s53
s_lshl_b32 s67, s67, 1
s_add_u32 s67, s67, s56
s_mul_i32 s67, s67, 7680
s_lshl_b32 s68, s46, 9
s_add_u32 s67, s67, s68
s_add_u32 m0, s57, 161792
s_nop 0
buffer_load_dwordx4 v23, s[28:31], s65 offen  lds
buffer_load_dword v21, v22, s[28:31], s67 offen
s_mov_b32 s34, 9437184
s_mov_b32 s35, 0x20000
v_lshlrev_b32 v4, 4, v0
v_lshlrev_b32 v7, 7, v1
v_lshl_add_u32 v7, v5, 3, v7
s_mul_i32 s66, s49, 49152
s_add_u32 s66, s66, s57
s_add_u32 s66, s66, 6291456
s_lshl_b32 s59, s49, 7
v_and_b32 v20, 6, v1
v_xor_b32 v20, v5, v20
v_mul_u32_u24 v17, 1280, v1
v_lshl_add_u32 v17, v20, 4, v17
s_add_u32 s68, s57, 161792
v_bfe_u32 v20, v0, 2, 2
v_lshrrev_b32 v19, 4, v0
v_lshl_add_u32 v20, v20, 2, v19
v_lshl_add_u32 v18, v20, 5, s68
v_and_b32 v20, 3, v0
v_lshl_add_u32 v18, v20, 3, v18
v_mul_u32_u24 v19, 49152, v19
v_and_b32 v20, 15, v0
v_lshl_add_u32 v19, v20, 4, v19
s_mul_i32 s61, s56, 196608
s_lshl_b32 s68, s2, 8
s_add_u32 s61, s61, s68
s_add_u32 s61, s61, 6291456
s_cmp_ge_u32 s2, 192
s_cselect_b32 s61, 0x40000000, s61
s_add_u32 s84, s32, 8257536
s_addc_u32 s85, s33, 0
s_load_dword s51, s[84:85], 0
s_getpc_b64 s[98:99]
L_tpc:
s_add_u32 s98, s98, L_table-L_tpc
s_addc_u32 s99, s99, 0
s_lshl_b32 s68, s49, 3
s_add_u32 s68, s68, s54
s_lshl_b32 s68, s68, 4
s_load_dwordx4 s[40:43], s[98:99], s68
s_add_u32 s62, s54, s55
s_and_b32 s62, s62, 3
s_mov_b32 s96, 1703092544
s_mov_b32 s97, 151
s_cmp_eq_u32 s62, 1
s_cselect_b32 s96, 1766008080, s96
s_cselect_b32 s97, 135, s97
s_cmp_eq_u32 s62, 2
s_cselect_b32 s96, 1967350288, s96
s_cselect_b32 s97, 152, s97
s_cmp_eq_u32 s62, 3
s_cselect_b32 s96, 1699164688, s96
s_cselect_b32 s97, 152, s97
s_bfe_u32 s69, s96, 0x40004
s_mul_i32 s69, s69, 128
s_add_u32 m0, s57, 16384
s_add_u32 s69, s69, s63
buffer_load_dwordx4 v2, s[20:23], s69 offen  lds
s_add_u32 m0, s57, 18432
s_add_u32 s69, s69, 20480
buffer_load_dwordx4 v2, s[20:23], s69 offen  lds
s_add_u32 m0, s57, 20480
s_add_u32 s69, s69, 20480
buffer_load_dwordx4 v2, s[20:23], s69 offen  lds
s_add_u32 m0, s57, 22528
s_add_u32 s69, s69, 20480
buffer_load_dwordx4 v2, s[20:23], s69 offen  lds
s_bfe_u32 s69, s96, 0x40004
s_mul_i32 s69, s69, 196608
s_add_u32 m0, s57, 24576
s_add_u32 s69, s69, s64
buffer_load_dwordx4 v3, s[24:27], s69 offen  lds
s_add_u32 m0, s57, 26624
s_add_u32 s69, s69, 49152
buffer_load_dwordx4 v3, s[24:27], s69 offen  lds
s_add_u32 m0, s57, 28672
s_add_u32 s69, s69, 49152
buffer_load_dwordx4 v3, s[24:27], s69 offen  lds
s_add_u32 m0, s57, 30720
s_add_u32 s69, s69, 49152
buffer_load_dwordx4 v3, s[24:27], s69 offen  lds
s_bfe_u32 s69, s96, 0x40008
s_mul_i32 s69, s69, 128
s_add_u32 m0, s57, 32768
s_add_u32 s69, s69, s63
buffer_load_dwordx4 v2, s[20:23], s69 offen  lds
s_add_u32 m0, s57, 34816
s_add_u32 s69, s69, 20480
buffer_load_dwordx4 v2, s[20:23], s69 offen  lds
s_add_u32 m0, s57, 36864
s_add_u32 s69, s69, 20480
buffer_load_dwordx4 v2, s[20:23], s69 offen  lds
s_add_u32 m0, s57, 38912
s_add_u32 s69, s69, 20480
buffer_load_dwordx4 v2, s[20:23], s69 offen  lds
s_bfe_u32 s69, s96, 0x40008
s_mul_i32 s69, s69, 196608
s_add_u32 m0, s57, 40960
s_add_u32 s69, s69, s64
buffer_load_dwordx4 v3, s[24:27], s69 offen  lds
s_add_u32 m0, s57, 43008
s_add_u32 s69, s69, 49152
buffer_load_dwordx4 v3, s[24:27], s69 offen  lds
s_add_u32 m0, s57, 45056
s_add_u32 s69, s69, 49152
buffer_load_dwordx4 v3, s[24:27], s69 offen  lds
s_add_u32 m0, s57, 47104
s_add_u32 s69, s69, 49152
buffer_load_dwordx4 v3, s[24:27], s69 offen  lds
s_waitcnt vmcnt(18)
s_barrier
s_bfe_u32 s69, s96, 0x4000c
s_mul_i32 s69, s69, 128
s_add_u32 m0, s57, 49152
s_add_u32 s69, s69, s63
buffer_load_dwordx4 v2, s[20:23], s69 offen  lds
s_add_u32 m0, s57, 51200
s_add_u32 s69, s69, 20480
buffer_load_dwordx4 v2, s[20:23], s69 offen  lds
s_add_u32 m0, s57, 53248
s_add_u32 s69, s69, 20480
buffer_load_dwordx4 v2, s[20:23], s69 offen  lds
s_add_u32 m0, s57, 55296
s_add_u32 s69, s69, 20480
buffer_load_dwordx4 v2, s[20:23], s69 offen  lds
s_bfe_u32 s69, s96, 0x4000c
s_mul_i32 s69, s69, 196608
s_add_u32 m0, s57, 57344
s_add_u32 s69, s69, s64
buffer_load_dwordx4 v3, s[24:27], s69 offen  lds
s_add_u32 m0, s57, 59392
s_add_u32 s69, s69, 49152
buffer_load_dwordx4 v3, s[24:27], s69 offen  lds
s_add_u32 m0, s57, 61440
s_add_u32 s69, s69, 49152
buffer_load_dwordx4 v3, s[24:27], s69 offen  lds
s_add_u32 m0, s57, 63488
s_add_u32 s69, s69, 49152
buffer_load_dwordx4 v3, s[24:27], s69 offen  lds
s_waitcnt lgkmcnt(0)
s_mul_i32 s51, s51, 1664525
s_add_u32 s51, s51, 1013904223
s_waitcnt vmcnt(16)
s_barrier
ds_read_b64_tr_b16 v[24:25], v18
ds_read_b64_tr_b16 v[26:27], v18 offset:512
s_bfe_u32 s69, s96, 0x40010
s_mul_i32 s69, s69, 128
s_add_u32 m0, s57, 0
s_add_u32 s69, s69, s63
buffer_load_dwordx4 v2, s[20:23], s69 offen  lds
s_add_u32 m0, s57, 2048
s_add_u32 s69, s69, 20480
buffer_load_dwordx4 v2, s[20:23], s69 offen  lds
s_add_u32 m0, s57, 4096
s_add_u32 s69, s69, 20480
buffer_load_dwordx4 v2, s[20:23], s69 offen  lds
s_add_u32 m0, s57, 6144
s_add_u32 s69, s69, 20480
buffer_load_dwordx4 v2, s[20:23], s69 offen  lds
s_waitcnt lgkmcnt(0)
buffer_store_dwordx4 v[24:27], v19, s[32:35], s61 offen sc1
s_bfe_u32 s69, s96, 0x40010
s_mul_i32 s69, s69, 196608
s_add_u32 m0, s57, 8192
s_add_u32 s69, s69, s64
buffer_load_dwordx4 v3, s[24:27], s69 offen  lds
s_add_u32 m0, s57, 10240
s_add_u32 s69, s69, 49152
buffer_load_dwordx4 v3, s[24:27], s69 offen  lds
s_add_u32 m0, s57, 12288
s_add_u32 s69, s69, 49152
buffer_load_dwordx4 v3, s[24:27], s69 offen  lds
s_add_u32 m0, s57, 14336
s_add_u32 s69, s69, 49152
buffer_load_dwordx4 v3, s[24:27], s69 offen  lds
s_waitcnt vmcnt(17)
s_barrier
s_bfe_u32 s69, s96, 0x40014
s_mul_i32 s69, s69, 128
s_add_u32 m0, s57, 16384
s_add_u32 s69, s69, s63
buffer_load_dwordx4 v2, s[20:23], s69 offen  lds
s_add_u32 m0, s57, 18432
s_add_u32 s69, s69, 20480
buffer_load_dwordx4 v2, s[20:23], s69 offen  lds
s_add_u32 m0, s57, 20480
s_add_u32 s69, s69, 20480
buffer_load_dwordx4 v2, s[20:23], s69 offen  lds
s_add_u32 m0, s57, 22528
s_add_u32 s69, s69, 20480
buffer_load_dwordx4 v2, s[20:23], s69 offen  lds
s_bfe_u32 s69, s96, 0x40014
s_mul_i32 s69, s69, 196608
s_add_u32 m0, s57, 24576
s_add_u32 s69, s69, s64
buffer_load_dwordx4 v3, s[24:27], s69 offen  lds
s_add_u32 m0, s57, 26624
s_add_u32 s69, s69, 49152
buffer_load_dwordx4 v3, s[24:27], s69 offen  lds
s_add_u32 m0, s57, 28672
s_add_u32 s69, s69, 49152
buffer_load_dwordx4 v3, s[24:27], s69 offen  lds
s_add_u32 m0, s57, 30720
s_add_u32 s69, s69, 49152
buffer_load_dwordx4 v3, s[24:27], s69 offen  lds
s_waitcnt vmcnt(17)
s_barrier
s_bfe_u32 s69, s96, 0x40018
s_mul_i32 s69, s69, 128
s_add_u32 m0, s57, 32768
s_add_u32 s69, s69, s63
buffer_load_dwordx4 v2, s[20:23], s69 offen  lds
s_add_u32 m0, s57, 34816
s_add_u32 s69, s69, 20480
buffer_load_dwordx4 v2, s[20:23], s69 offen  lds
s_add_u32 m0, s57, 36864
s_add_u32 s69, s69, 20480
buffer_load_dwordx4 v2, s[20:23], s69 offen  lds
s_add_u32 m0, s57, 38912
s_add_u32 s69, s69, 20480
buffer_load_dwordx4 v2, s[20:23], s69 offen  lds
s_bfe_u32 s69, s96, 0x40018
s_mul_i32 s69, s69, 196608
s_add_u32 m0, s57, 40960
s_add_u32 s69, s69, s64
buffer_load_dwordx4 v3, s[24:27], s69 offen  lds
s_add_u32 m0, s57, 43008
s_add_u32 s69, s69, 49152
buffer_load_dwordx4 v3, s[24:27], s69 offen  lds
s_add_u32 m0, s57, 45056
s_add_u32 s69, s69, 49152
buffer_load_dwordx4 v3, s[24:27], s69 offen  lds
s_add_u32 m0, s57, 47104
s_add_u32 s69, s69, 49152
buffer_load_dwordx4 v3, s[24:27], s69 offen  lds
s_waitcnt vmcnt(16)
s_barrier
s_and_b32 s88, s2, 15
s_lshl_b32 s88, s88, 7
s_lshr_b32 s87, s2, 4
s_lshl_b32 s87, s87, 2
s_add_u32 s88, s88, s87
s_add_u32 s88, s88, 4096
s_lshl_b32 s87, s2, 6
s_add_u32 s87, s87, 0x1a000
s_cmp_eq_u32 s56, 0
s_cselect_b32 s88, s88, s87
s_atomic_swap s51, s[84:85], s88
s_bfe_u32 s69, s96, 0x4001c
s_mul_i32 s69, s69, 128
s_add_u32 m0, s57, 49152
s_add_u32 s69, s69, s63
buffer_load_dwordx4 v2, s[20:23], s69 offen  lds
s_add_u32 m0, s57, 51200
s_add_u32 s69, s69, 20480
buffer_load_dwordx4 v2, s[20:23], s69 offen  lds
s_add_u32 m0, s57, 53248
s_add_u32 s69, s69, 20480
buffer_load_dwordx4 v2, s[20:23], s69 offen  lds
s_add_u32 m0, s57, 55296
s_add_u32 s69, s69, 20480
buffer_load_dwordx4 v2, s[20:23], s69 offen  lds
s_bfe_u32 s69, s96, 0x4001c
s_mul_i32 s69, s69, 196608
s_add_u32 m0, s57, 57344
s_add_u32 s69, s69, s64
buffer_load_dwordx4 v3, s[24:27], s69 offen  lds
s_add_u32 m0, s57, 59392
s_add_u32 s69, s69, 49152
buffer_load_dwordx4 v3, s[24:27], s69 offen  lds
s_add_u32 m0, s57, 61440
s_add_u32 s69, s69, 49152
buffer_load_dwordx4 v3, s[24:27], s69 offen  lds
s_add_u32 m0, s57, 63488
s_add_u32 s69, s69, 49152
buffer_load_dwordx4 v3, s[24:27], s69 offen  lds
s_waitcnt vmcnt(16)
s_barrier
s_branch L_pg0
.p2align 12
L_stub0:
s_setpc_b64 s[66:67]
s_nop 0
L_pg0:
s_bfe_u32 s69, s97, 0x40000
s_mul_i32 s69, s69, 128
s_add_u32 m0, s57, 0
s_add_u32 s69, s69, s63
buffer_load_dwordx4 v2, s[20:23], s69 offen  lds
s_add_u32 m0, s57, 2048
s_add_u32 s69, s69, 20480
buffer_load_dwordx4 v2, s[20:23], s69 offen  lds
s_add_u32 m0, s57, 4096
s_add_u32 s69, s69, 20480
buffer_load_dwordx4 v2, s[20:23], s69 offen  lds
s_add_u32 m0, s57, 6144
s_add_u32 s69, s69, 20480
buffer_load_dwordx4 v2, s[20:23], s69 offen  lds
s_bfe_u32 s69, s97, 0x40000
s_mul_i32 s69, s69, 196608
s_add_u32 m0, s57, 8192
s_add_u32 s69, s69, s64
buffer_load_dwordx4 v3, s[24:27], s69 offen  lds
s_add_u32 m0, s57, 10240
s_add_u32 s69, s69, 49152
buffer_load_dwordx4 v3, s[24:27], s69 offen  lds
s_add_u32 m0, s57, 12288
s_add_u32 s69, s69, 49152
buffer_load_dwordx4 v3, s[24:27], s69 offen  lds
s_add_u32 m0, s57, 14336
s_add_u32 s69, s69, 49152
buffer_load_dwordx4 v3, s[24:27], s69 offen  lds
s_waitcnt vmcnt(16)
s_barrier
s_bfe_u32 s69, s97, 0x40004
s_mul_i32 s69, s69, 128
s_add_u32 m0, s57, 16384
s_add_u32 s69, s69, s63
buffer_load_dwordx4 v2, s[20:23], s69 offen  lds
s_add_u32 m0, s57, 18432
s_add_u32 s69, s69, 20480
buffer_load_dwordx4 v2, s[20:23], s69 offen  lds
s_add_u32 m0, s57, 20480
s_add_u32 s69, s69, 20480
buffer_load_dwordx4 v2, s[20:23], s69 offen  lds
s_add_u32 m0, s57, 22528
s_add_u32 s69, s69, 20480
buffer_load_dwordx4 v2, s[20:23], s69 offen  lds
s_bfe_u32 s69, s97, 0x40004
s_mul_i32 s69, s69, 196608
s_add_u32 m0, s57, 24576
s_add_u32 s69, s69, s64
buffer_load_dwordx4 v3, s[24:27], s69 offen  lds
s_add_u32 m0, s57, 26624
s_add_u32 s69, s69, 49152
buffer_load_dwordx4 v3, s[24:27], s69 offen  lds
s_add_u32 m0, s57, 28672
s_add_u32 s69, s69, 49152
buffer_load_dwordx4 v3, s[24:27], s69 offen  lds
s_add_u32 m0, s57, 30720
s_add_u32 s69, s69, 49152
buffer_load_dwordx4 v3, s[24:27], s69 offen  lds
s_waitcnt vmcnt(16)
s_barrier
s_add_u32 m0, s57, 32768
s_add_u32 s69, s64, 128
buffer_load_dwordx4 v3, s[24:27], s69 offen  lds
s_add_u32 m0, s57, 34816
s_add_u32 s69, s69, 49152
buffer_load_dwordx4 v3, s[24:27], s69 offen  lds
s_add_u32 m0, s57, 36864
s_add_u32 s69, s69, 49152
buffer_load_dwordx4 v3, s[24:27], s69 offen  lds
s_add_u32 m0, s57, 38912
s_add_u32 s69, s69, 49152
buffer_load_dwordx4 v3, s[24:27], s69 offen  lds
s_bfe_u32 s69, s96, 0x40004
s_mul_i32 s69, s69, 196608
s_add_u32 s69, s69, 128
s_add_u32 m0, s57, 40960
s_add_u32 s69, s69, s64
buffer_load_dwordx4 v3, s[24:27], s69 offen  lds
s_add_u32 m0, s57, 43008
s_add_u32 s69, s69, 49152
buffer_load_dwordx4 v3, s[24:27], s69 offen  lds
s_add_u32 m0, s57, 45056
s_add_u32 s69, s69, 49152
buffer_load_dwordx4 v3, s[24:27], s69 offen  lds
s_add_u32 m0, s57, 47104
s_add_u32 s69, s69, 49152
buffer_load_dwordx4 v3, s[24:27], s69 offen  lds
s_waitcnt vmcnt(16)
s_barrier
s_bfe_u32 s69, s96, 0x40008
s_mul_i32 s69, s69, 196608
s_add_u32 s69, s69, 128
s_add_u32 m0, s57, 49152
s_add_u32 s69, s69, s64
buffer_load_dwordx4 v3, s[24:27], s69 offen  lds
s_add_u32 m0, s57, 51200
s_add_u32 s69, s69, 49152
buffer_load_dwordx4 v3, s[24:27], s69 offen  lds
s_add_u32 m0, s57, 53248
s_add_u32 s69, s69, 49152
buffer_load_dwordx4 v3, s[24:27], s69 offen  lds
s_add_u32 m0, s57, 55296
s_add_u32 s69, s69, 49152
buffer_load_dwordx4 v3, s[24:27], s69 offen  lds
s_bfe_u32 s69, s96, 0x4000c
s_mul_i32 s69, s69, 196608
s_add_u32 s69, s69, 128
s_add_u32 m0, s57, 57344
s_add_u32 s69, s69, s64
buffer_load_dwordx4 v3, s[24:27], s69 offen  lds
s_add_u32 m0, s57, 59392
s_add_u32 s69, s69, 49152
buffer_load_dwordx4 v3, s[24:27], s69 offen  lds
s_add_u32 m0, s57, 61440
s_add_u32 s69, s69, 49152
buffer_load_dwordx4 v3, s[24:27], s69 offen  lds
s_add_u32 m0, s57, 63488
s_add_u32 s69, s69, 49152
buffer_load_dwordx4 v3, s[24:27], s69 offen  lds
s_waitcnt vmcnt(16)
s_barrier
s_bfe_u32 s69, s96, 0x40010
s_mul_i32 s69, s69, 196608
s_add_u32 s69, s69, 128
s_add_u32 m0, s57, 0
s_add_u32 s69, s69, s64
buffer_load_dwordx4 v3, s[24:27], s69 offen  lds
s_add_u32 m0, s57, 2048
s_add_u32 s69, s69, 49152
buffer_load_dwordx4 v3, s[24:27], s69 offen  lds
s_add_u32 m0, s57, 4096
s_add_u32 s69, s69, 49152
buffer_load_dwordx4 v3, s[24:27], s69 offen  lds
s_add_u32 m0, s57, 6144
s_add_u32 s69, s69, 49152
buffer_load_dwordx4 v3, s[24:27], s69 offen  lds
s_bfe_u32 s69, s96, 0x40014
s_mul_i32 s69, s69, 196608
s_add_u32 s69, s69, 128
s_add_u32 m0, s57, 8192
s_add_u32 s69, s69, s64
buffer_load_dwordx4 v3, s[24:27], s69 offen  lds
s_add_u32 m0, s57, 10240
s_add_u32 s69, s69, 49152
buffer_load_dwordx4 v3, s[24:27], s69 offen  lds
s_add_u32 m0, s57, 12288
s_add_u32 s69, s69, 49152
buffer_load_dwordx4 v3, s[24:27], s69 offen  lds
s_add_u32 m0, s57, 14336
s_add_u32 s69, s69, 49152
buffer_load_dwordx4 v3, s[24:27], s69 offen  lds
s_waitcnt vmcnt(16)
s_barrier
s_bfe_u32 s69, s96, 0x40018
s_mul_i32 s69, s69, 196608
s_add_u32 s69, s69, 128
s_add_u32 m0, s57, 16384
s_add_u32 s69, s69, s64
buffer_load_dwordx4 v3, s[24:27], s69 offen  lds
s_add_u32 m0, s57, 18432
s_add_u32 s69, s69, 49152
buffer_load_dwordx4 v3, s[24:27], s69 offen  lds
s_add_u32 m0, s57, 20480
s_add_u32 s69, s69, 49152
buffer_load_dwordx4 v3, s[24:27], s69 offen  lds
s_add_u32 m0, s57, 22528
s_add_u32 s69, s69, 49152
buffer_load_dwordx4 v3, s[24:27], s69 offen  lds
s_bfe_u32 s69, s96, 0x4001c
s_mul_i32 s69, s69, 196608
s_add_u32 s69, s69, 128
s_add_u32 m0, s57, 24576
s_add_u32 s69, s69, s64
buffer_load_dwordx4 v3, s[24:27], s69 offen  lds
s_add_u32 m0, s57, 26624
s_add_u32 s69, s69, 49152
buffer_load_dwordx4 v3, s[24:27], s69 offen  lds
s_add_u32 m0, s57, 28672
s_add_u32 s69, s69, 49152
buffer_load_dwordx4 v3, s[24:27], s69 offen  lds
s_add_u32 m0, s57, 30720
s_add_u32 s69, s69, 49152
buffer_load_dwordx4 v3, s[24:27], s69 offen  lds
s_bfe_u32 s69, s97, 0x40000
s_mul_i32 s69, s69, 196608
s_add_u32 s69, s69, 128
s_add_u32 m0, s57, 65536
s_add_u32 s69, s69, s64
buffer_load_dwordx4 v3, s[24:27], s69 offen  lds
s_add_u32 m0, s57, 67584
s_add_u32 s69, s69, 49152
buffer_load_dwordx4 v3, s[24:27], s69 offen  lds
s_add_u32 m0, s57, 69632
s_add_u32 s69, s69, 49152
buffer_load_dwordx4 v3, s[24:27], s69 offen  lds
s_add_u32 m0, s57, 71680
s_add_u32 s69, s69, 49152
buffer_load_dwordx4 v3, s[24:27], s69 offen  lds
s_bfe_u32 s69, s97, 0x40004
s_mul_i32 s69, s69, 196608
s_add_u32 s69, s69, 128
s_add_u32 m0, s57, 73728
s_add_u32 s69, s69, s64
buffer_load_dwordx4 v3, s[24:27], s69 offen  lds
s_add_u32 m0, s57, 75776
s_add_u32 s69, s69, 49152
buffer_load_dwordx4 v3, s[24:27], s69 offen  lds
s_add_u32 m0, s57, 77824
s_add_u32 s69, s69, 49152
buffer_load_dwordx4 v3, s[24:27], s69 offen  lds
s_add_u32 m0, s57, 79872
s_add_u32 s69, s69, 49152
buffer_load_dwordx4 v3, s[24:27], s69 offen  lds
s_add_u32 m0, s57, 81920
s_add_u32 s69, s64, 256
buffer_load_dwordx4 v3, s[24:27], s69 offen  lds
s_add_u32 m0, s57, 83968
s_add_u32 s69, s69, 49152
buffer_load_dwordx4 v3, s[24:27], s69 offen  lds
s_add_u32 m0, s57, 86016
s_add_u32 s69, s69, 49152
buffer_load_dwordx4 v3, s[24:27], s69 offen  lds
s_add_u32 m0, s57, 88064
s_add_u32 s69, s69, 49152
buffer_load_dwordx4 v3, s[24:27], s69 offen  lds
s_bfe_u32 s69, s96, 0x40004
s_mul_i32 s69, s69, 196608
s_add_u32 s69, s69, 256
s_add_u32 m0, s57, 90112
s_add_u32 s69, s69, s64
buffer_load_dwordx4 v3, s[24:27], s69 offen  lds
s_add_u32 m0, s57, 92160
s_add_u32 s69, s69, 49152
buffer_load_dwordx4 v3, s[24:27], s69 offen  lds
s_add_u32 m0, s57, 94208
s_add_u32 s69, s69, 49152
buffer_load_dwordx4 v3, s[24:27], s69 offen  lds
s_add_u32 m0, s57, 96256
s_add_u32 s69, s69, 49152
buffer_load_dwordx4 v3, s[24:27], s69 offen  lds
s_bfe_u32 s69, s96, 0x40008
s_mul_i32 s69, s69, 196608
s_add_u32 s69, s69, 256
s_add_u32 m0, s57, 98304
s_add_u32 s69, s69, s64
buffer_load_dwordx4 v3, s[24:27], s69 offen  lds
s_add_u32 m0, s57, 100352
s_add_u32 s69, s69, 49152
buffer_load_dwordx4 v3, s[24:27], s69 offen  lds
s_waitcnt vmcnt(34)
s_barrier
s_bfe_u32 s69, s96, 0x40008
s_mul_i32 s69, s69, 196608
s_add_u32 s69, s69, 98560
s_add_u32 m0, s57, 102400
s_add_u32 s69, s69, s64
buffer_load_dwordx4 v3, s[24:27], s69 offen  lds
s_add_u32 m0, s57, 104448
s_add_u32 s69, s69, 49152
buffer_load_dwordx4 v3, s[24:27], s69 offen  lds
s_bfe_u32 s69, s96, 0x4000c
s_mul_i32 s69, s69, 196608
s_add_u32 s69, s69, 256
s_add_u32 m0, s57, 32768
s_add_u32 s69, s69, s64
buffer_load_dwordx4 v3, s[24:27], s69 offen  lds
s_add_u32 m0, s57, 34816
s_add_u32 s69, s69, 49152
buffer_load_dwordx4 v3, s[24:27], s69 offen  lds
s_add_u32 m0, s57, 36864
s_add_u32 s69, s69, 49152
buffer_load_dwordx4 v3, s[24:27], s69 offen  lds
s_add_u32 m0, s57, 38912
s_add_u32 s69, s69, 49152
buffer_load_dwordx4 v3, s[24:27], s69 offen  lds
s_bfe_u32 s69, s96, 0x40010
s_mul_i32 s69, s69, 196608
s_add_u32 s69, s69, 256
s_add_u32 m0, s57, 40960
s_add_u32 s69, s69, s64
buffer_load_dwordx4 v3, s[24:27], s69 offen  lds
s_waitcnt vmcnt(33)
s_barrier
s_bfe_u32 s69, s96, 0x40010
s_mul_i32 s69, s69, 196608
s_add_u32 s69, s69, 49408
s_add_u32 m0, s57, 43008
s_add_u32 s69, s69, s64
buffer_load_dwordx4 v3, s[24:27], s69 offen  lds
s_add_u32 m0, s57, 45056
s_add_u32 s69, s69, 49152
buffer_load_dwordx4 v3, s[24:27], s69 offen  lds
s_add_u32 m0, s57, 47104
s_add_u32 s69, s69, 49152
buffer_load_dwordx4 v3, s[24:27], s69 offen  lds
s_bfe_u32 s69, s96, 0x40014
s_mul_i32 s69, s69, 196608
s_add_u32 s69, s69, 256
s_add_u32 m0, s57, 49152
s_add_u32 s69, s69, s64
buffer_load_dwordx4 v3, s[24:27], s69 offen  lds
s_add_u32 m0, s57, 51200
s_add_u32 s69, s69, 49152
buffer_load_dwordx4 v3, s[24:27], s69 offen  lds
s_add_u32 m0, s57, 53248
s_add_u32 s69, s69, 49152
buffer_load_dwordx4 v3, s[24:27], s69 offen  lds
s_add_u32 m0, s57, 55296
s_add_u32 s69, s69, 49152
buffer_load_dwordx4 v3, s[24:27], s69 offen  lds
s_waitcnt vmcnt(32)
s_barrier
s_bfe_u32 s69, s96, 0x40018
s_mul_i32 s69, s69, 196608
s_add_u32 s69, s69, 256
s_add_u32 m0, s57, 0
s_add_u32 s69, s69, s64
buffer_load_dwordx4 v3, s[24:27], s69 offen  lds
s_add_u32 m0, s57, 2048
s_add_u32 s69, s69, 49152
buffer_load_dwordx4 v3, s[24:27], s69 offen  lds
s_add_u32 m0, s57, 4096
s_add_u32 s69, s69, 49152
buffer_load_dwordx4 v3, s[24:27], s69 offen  lds
s_add_u32 m0, s57, 6144
s_add_u32 s69, s69, 49152
buffer_load_dwordx4 v3, s[24:27], s69 offen  lds
s_bfe_u32 s69, s96, 0x4001c
s_mul_i32 s69, s69, 196608
s_add_u32 s69, s69, 256
s_add_u32 m0, s57, 8192
s_add_u32 s69, s69, s64
buffer_load_dwordx4 v3, s[24:27], s69 offen  lds
s_add_u32 m0, s57, 10240
s_add_u32 s69, s69, 49152
buffer_load_dwordx4 v3, s[24:27], s69 offen  lds
s_add_u32 m0, s57, 12288
s_add_u32 s69, s69, 49152
buffer_load_dwordx4 v3, s[24:27], s69 offen  lds
s_waitcnt vmcnt(31)
s_barrier
s_mov_b32 s73, 8261632
buffer_load_dwordx2 v[8:9], v7, s[32:35], s73 offen sc1
s_bfe_u32 s69, s96, 0x4001c
s_mul_i32 s69, s69, 196608
s_add_u32 s69, s69, 147712
s_add_u32 m0, s57, 14336
s_add_u32 s69, s69, s64
buffer_load_dwordx4 v3, s[24:27], s69 offen  lds
s_bfe_u32 s69, s97, 0x40000
s_mul_i32 s69, s69, 196608
s_add_u32 s69, s69, 256
s_add_u32 m0, s57, 16384
s_add_u32 s69, s69, s64
buffer_load_dwordx4 v3, s[24:27], s69 offen  lds
s_add_u32 m0, s57, 18432
s_add_u32 s69, s69, 49152
buffer_load_dwordx4 v3, s[24:27], s69 offen  lds
s_add_u32 m0, s57, 20480
s_add_u32 s69, s69, 49152
buffer_load_dwordx4 v3, s[24:27], s69 offen  lds
s_add_u32 m0, s57, 22528
s_add_u32 s69, s69, 49152
buffer_load_dwordx4 v3, s[24:27], s69 offen  lds
s_bfe_u32 s69, s97, 0x40004
s_mul_i32 s69, s69, 196608
s_add_u32 s69, s69, 256
s_add_u32 m0, s57, 24576
s_add_u32 s69, s69, s64
buffer_load_dwordx4 v3, s[24:27], s69 offen  lds
s_add_u32 m0, s57, 26624
s_add_u32 s69, s69, 49152
buffer_load_dwordx4 v3, s[24:27], s69 offen  lds
s_waitcnt vmcnt(31)
s_barrier
s_bfe_u32 s69, s97, 0x40004
s_mul_i32 s69, s69, 196608
s_add_u32 s69, s69, 98560
s_add_u32 m0, s57, 28672
s_add_u32 s69, s69, s64
buffer_load_dwordx4 v3, s[24:27], s69 offen  lds
s_add_u32 m0, s57, 30720
s_add_u32 s69, s69, 49152
buffer_load_dwordx4 v3, s[24:27], s69 offen  lds
s_bfe_u32 s69, s40, 0x50000
s_mul_i32 s69, s69, 81920
s_add_u32 m0, s57, 153600
s_add_u32 s69, s69, s59
buffer_load_dwordx4 v17, s[28:31], s69 offen  lds
s_add_u32 m0, s57, 155648
s_add_u32 s69, s69, 20480
buffer_load_dwordx4 v17, s[28:31], s69 offen  lds
s_add_u32 m0, s57, 157696
s_add_u32 s69, s69, 20480
buffer_load_dwordx4 v17, s[28:31], s69 offen  lds
s_add_u32 m0, s57, 159744
s_add_u32 s69, s69, 20480
buffer_load_dwordx4 v17, s[28:31], s69 offen  lds
s_bfe_u32 s69, s40, 0x50005
s_mul_i32 s69, s69, 81920
s_add_u32 m0, s57, 143360
s_add_u32 s69, s69, s59
buffer_load_dwordx4 v17, s[28:31], s69 offen  lds
s_add_u32 m0, s57, 145408
s_add_u32 s69, s69, 20480
buffer_load_dwordx4 v17, s[28:31], s69 offen  lds
s_add_u32 m0, s57, 147456
s_add_u32 s69, s69, 20480
buffer_load_dwordx4 v17, s[28:31], s69 offen  lds
s_add_u32 m0, s57, 149504
s_add_u32 s69, s69, 20480
buffer_load_dwordx4 v17, s[28:31], s69 offen  lds
s_bfe_u32 s69, s40, 0x5000a
s_mul_i32 s69, s69, 81920
s_add_u32 m0, s57, 133120
s_add_u32 s69, s69, s59
buffer_load_dwordx4 v17, s[28:31], s69 offen  lds
s_add_u32 m0, s57, 135168
s_add_u32 s69, s69, 20480
buffer_load_dwordx4 v17, s[28:31], s69 offen  lds
s_add_u32 m0, s57, 137216
s_add_u32 s69, s69, 20480
buffer_load_dwordx4 v17, s[28:31], s69 offen  lds
s_add_u32 m0, s57, 139264
s_add_u32 s69, s69, 20480
buffer_load_dwordx4 v17, s[28:31], s69 offen  lds
s_bfe_u32 s69, s40, 0x5000f
s_mul_i32 s69, s69, 81920
s_add_u32 m0, s57, 122880
s_add_u32 s69, s69, s59
buffer_load_dwordx4 v17, s[28:31], s69 offen  lds
s_add_u32 m0, s57, 124928
s_add_u32 s69, s69, 20480
buffer_load_dwordx4 v17, s[28:31], s69 offen  lds
s_add_u32 m0, s57, 126976
s_add_u32 s69, s69, 20480
buffer_load_dwordx4 v17, s[28:31], s69 offen  lds
s_add_u32 m0, s57, 129024
s_add_u32 s69, s69, 20480
buffer_load_dwordx4 v17, s[28:31], s69 offen  lds
s_bfe_u32 s69, s40, 0x50014
s_mul_i32 s69, s69, 81920
s_add_u32 m0, s57, 112640
s_add_u32 s69, s69, s59
buffer_load_dwordx4 v17, s[28:31], s69 offen  lds
s_add_u32 m0, s57, 114688
s_add_u32 s69, s69, 20480
buffer_load_dwordx4 v17, s[28:31], s69 offen  lds
s_add_u32 m0, s57, 116736
s_add_u32 s69, s69, 20480
buffer_load_dwordx4 v17, s[28:31], s69 offen  lds
s_add_u32 m0, s57, 118784
s_add_u32 s69, s69, 20480
buffer_load_dwordx4 v17, s[28:31], s69 offen  lds
s_bfe_u32 s69, s40, 0x50019
s_mul_i32 s69, s69, 81920
s_add_u32 m0, s57, 71680
s_add_u32 s69, s69, s59
buffer_load_dwordx4 v17, s[28:31], s69 offen  lds
s_add_u32 m0, s57, 73728
s_add_u32 s69, s69, 20480
buffer_load_dwordx4 v17, s[28:31], s69 offen  lds
s_add_u32 m0, s57, 75776
s_add_u32 s69, s69, 20480
buffer_load_dwordx4 v17, s[28:31], s69 offen  lds
s_add_u32 m0, s57, 77824
s_add_u32 s69, s69, 20480
buffer_load_dwordx4 v17, s[28:31], s69 offen  lds
s_waitcnt vmcnt(33)
s_mov_b32 s72, 262144
v_cmp_ne_u32 vcc, s51, v8
v_cmp_ne_u32 s[74:75], s51, v9
s_nop 1
s_or_b64 vcc, vcc, s[74:75]
s_cbranch_scc1 L_f0chk
L_f0ok:
s_barrier
s_or_b32 s87, s2, s56
s_cbranch_scc0 L_epu
L_epr:
s_bfe_u32 s69, s40, 0x50000
s_lshl_b32 s69, s69, 11
s_add_u32 m0, s57, 161792
s_add_u32 s69, s69, s66
buffer_load_dwordx4 v4, s[32:35], s69 offen sc1 lds
s_bfe_u32 s69, s40, 0x50005
s_lshl_b32 s69, s69, 11
s_add_u32 m0, s57, 151552
s_add_u32 s69, s69, s66
buffer_load_dwordx4 v4, s[32:35], s69 offen sc1 lds
s_bfe_u32 s69, s40, 0x5000a
s_lshl_b32 s69, s69, 11
s_add_u32 m0, s57, 141312
s_add_u32 s69, s69, s66
buffer_load_dwordx4 v4, s[32:35], s69 offen sc1 lds
s_bfe_u32 s69, s40, 0x5000f
s_lshl_b32 s69, s69, 11
s_add_u32 m0, s57, 131072
s_add_u32 s69, s69, s66
buffer_load_dwordx4 v4, s[32:35], s69 offen sc1 lds
s_bfe_u32 s69, s40, 0x50014
s_lshl_b32 s69, s69, 11
s_add_u32 m0, s57, 120832
s_add_u32 s69, s69, s66
buffer_load_dwordx4 v4, s[32:35], s69 offen sc1 lds
s_bfe_u32 s69, s40, 0x50019
s_lshl_b32 s69, s69, 11
s_add_u32 m0, s57, 79872
s_add_u32 s69, s69, s66
buffer_load_dwordx4 v4, s[32:35], s69 offen sc1 lds
s_bfe_u32 s69, s41, 0x50000
s_mul_i32 s69, s69, 81920
s_add_u32 m0, s57, 81920
s_add_u32 s69, s69, s59
buffer_load_dwordx4 v17, s[28:31], s69 offen  lds
s_barrier
s_bfe_u32 s69, s41, 0x50000
s_mul_i32 s69, s69, 81920
s_add_u32 s69, s69, 20480
s_add_u32 m0, s57, 83968
s_add_u32 s69, s69, s59
buffer_load_dwordx4 v17, s[28:31], s69 offen  lds
s_add_u32 m0, s57, 86016
s_add_u32 s69, s69, 20480
buffer_load_dwordx4 v17, s[28:31], s69 offen  lds
s_add_u32 m0, s57, 88064
s_add_u32 s69, s69, 20480
buffer_load_dwordx4 v17, s[28:31], s69 offen  lds
s_bfe_u32 s69, s41, 0x50000
s_lshl_b32 s69, s69, 11
s_add_u32 m0, s57, 90112
s_add_u32 s69, s69, s66
buffer_load_dwordx4 v4, s[32:35], s69 offen sc1 lds
s_bfe_u32 s69, s41, 0x50005
s_mul_i32 s69, s69, 81920
s_add_u32 m0, s57, 102400
s_add_u32 s69, s69, s59
buffer_load_dwordx4 v17, s[28:31], s69 offen  lds
s_add_u32 m0, s57, 104448
s_add_u32 s69, s69, 20480
buffer_load_dwordx4 v17, s[28:31], s69 offen  lds
s_add_u32 m0, s57, 106496
s_add_u32 s69, s69, 20480
buffer_load_dwordx4 v17, s[28:31], s69 offen  lds
s_branch L_pg1
.p2align 12
L_stub1:
s_setpc_b64 s[66:67]
s_nop 0
L_pg1:
s_waitcnt vmcnt(46)
s_barrier
s_bfe_u32 s69, s41, 0x50005
s_mul_i32 s69, s69, 81920
s_add_u32 s69, s69, 61440
s_add_u32 m0, s57, 108544
s_add_u32 s69, s69, s59
buffer_load_dwordx4 v17, s[28:31], s69 offen  lds
s_bfe_u32 s69, s41, 0x50005
s_lshl_b32 s69, s69, 11
s_add_u32 m0, s57, 110592
s_add_u32 s69, s69, s66
buffer_load_dwordx4 v4, s[32:35], s69 offen sc1 lds
s_bfe_u32 s69, s41, 0x5000a
s_mul_i32 s69, s69, 81920
s_add_u32 m0, s57, 92160
s_add_u32 s69, s69, s59
buffer_load_dwordx4 v17, s[28:31], s69 offen  lds
s_add_u32 m0, s57, 94208
s_add_u32 s69, s69, 20480
buffer_load_dwordx4 v17, s[28:31], s69 offen  lds
s_add_u32 m0, s57, 96256
s_add_u32 s69, s69, 20480
buffer_load_dwordx4 v17, s[28:31], s69 offen  lds
s_add_u32 m0, s57, 98304
s_add_u32 s69, s69, 20480
buffer_load_dwordx4 v17, s[28:31], s69 offen  lds
s_bfe_u32 s69, s41, 0x5000a
s_lshl_b32 s69, s69, 11
s_add_u32 m0, s57, 100352
s_add_u32 s69, s69, s66
buffer_load_dwordx4 v4, s[32:35], s69 offen sc1 lds
s_waitcnt vmcnt(45)
s_barrier
s_bfe_u32 s69, s41, 0x5000f
s_mul_i32 s69, s69, 81920
s_add_u32 m0, s57, 61440
s_add_u32 s69, s69, s59
buffer_load_dwordx4 v17, s[28:31], s69 offen  lds
s_add_u32 m0, s57, 63488
s_add_u32 s69, s69, 20480
buffer_load_dwordx4 v17, s[28:31], s69 offen  lds
s_add_u32 m0, s57, 65536
s_add_u32 s69, s69, 20480
buffer_load_dwordx4 v17, s[28:31], s69 offen  lds
s_add_u32 m0, s57, 67584
s_add_u32 s69, s69, 20480
buffer_load_dwordx4 v17, s[28:31], s69 offen  lds
s_bfe_u32 s69, s41, 0x5000f
s_lshl_b32 s69, s69, 11
s_add_u32 m0, s57, 69632
s_add_u32 s69, s69, s66
buffer_load_dwordx4 v4, s[32:35], s69 offen sc1 lds
s_bfe_u32 s69, s41, 0x50014
s_mul_i32 s69, s69, 81920
s_add_u32 m0, s57, 51200
s_add_u32 s69, s69, s59
buffer_load_dwordx4 v17, s[28:31], s69 offen  lds
s_add_u32 m0, s57, 53248
s_add_u32 s69, s69, 20480
buffer_load_dwordx4 v17, s[28:31], s69 offen  lds
s_add_u32 m0, s57, 55296
s_add_u32 s69, s69, 20480
buffer_load_dwordx4 v17, s[28:31], s69 offen  lds
s_waitcnt vmcnt(26)
s_barrier
s_bfe_u32 s69, s41, 0x50014
s_mul_i32 s69, s69, 81920
s_add_u32 s69, s69, 61440
s_add_u32 m0, s57, 57344
s_add_u32 s69, s69, s59
buffer_load_dwordx4 v17, s[28:31], s69 offen  lds
s_bfe_u32 s69, s41, 0x50014
s_lshl_b32 s69, s69, 11
s_add_u32 m0, s57, 59392
s_add_u32 s69, s69, s66
buffer_load_dwordx4 v4, s[32:35], s69 offen sc1 lds
s_bfe_u32 s69, s41, 0x50019
s_mul_i32 s69, s69, 81920
s_add_u32 m0, s57, 40960
s_add_u32 s69, s69, s59
buffer_load_dwordx4 v17, s[28:31], s69 offen  lds
s_add_u32 m0, s57, 43008
s_add_u32 s69, s69, 20480
buffer_load_dwordx4 v17, s[28:31], s69 offen  lds
s_add_u32 m0, s57, 45056
s_add_u32 s69, s69, 20480
buffer_load_dwordx4 v17, s[28:31], s69 offen  lds
s_add_u32 m0, s57, 47104
s_add_u32 s69, s69, 20480
buffer_load_dwordx4 v17, s[28:31], s69 offen  lds
s_bfe_u32 s69, s41, 0x50019
s_lshl_b32 s69, s69, 11
s_add_u32 m0, s57, 49152
s_add_u32 s69, s69, s66
buffer_load_dwordx4 v4, s[32:35], s69 offen sc1 lds
s_bfe_u32 s69, s42, 0x50000
s_mul_i32 s69, s69, 81920
s_add_u32 m0, s57, 30720
s_add_u32 s69, s69, s59
buffer_load_dwordx4 v17, s[28:31], s69 offen  lds
s_add_u32 m0, s57, 32768
s_add_u32 s69, s69, 20480
buffer_load_dwordx4 v17, s[28:31], s69 offen  lds
s_add_u32 m0, s57, 34816
s_add_u32 s69, s69, 20480
buffer_load_dwordx4 v17, s[28:31], s69 offen  lds
s_add_u32 m0, s57, 36864
s_add_u32 s69, s69, 20480
buffer_load_dwordx4 v17, s[28:31], s69 offen  lds
s_bfe_u32 s69, s42, 0x50000
s_lshl_b32 s69, s69, 11
s_add_u32 m0, s57, 38912
s_add_u32 s69, s69, s66
buffer_load_dwordx4 v4, s[32:35], s69 offen sc1 lds
s_bfe_u32 s69, s42, 0x50005
s_mul_i32 s69, s69, 81920
s_add_u32 m0, s57, 20480
s_add_u32 s69, s69, s59
buffer_load_dwordx4 v17, s[28:31], s69 offen  lds
s_add_u32 m0, s57, 22528
s_add_u32 s69, s69, 20480
buffer_load_dwordx4 v17, s[28:31], s69 offen  lds
s_add_u32 m0, s57, 24576
s_add_u32 s69, s69, 20480
buffer_load_dwordx4 v17, s[28:31], s69 offen  lds
s_add_u32 m0, s57, 26624
s_add_u32 s69, s69, 20480
buffer_load_dwordx4 v17, s[28:31], s69 offen  lds
s_bfe_u32 s69, s42, 0x50005
s_lshl_b32 s69, s69, 11
s_add_u32 m0, s57, 28672
s_add_u32 s69, s69, s66
buffer_load_dwordx4 v4, s[32:35], s69 offen sc1 lds
s_bfe_u32 s69, s42, 0x5000a
s_mul_i32 s69, s69, 81920
s_add_u32 m0, s57, 10240
s_add_u32 s69, s69, s59
buffer_load_dwordx4 v17, s[28:31], s69 offen  lds
s_waitcnt vmcnt(42)
s_barrier
s_bfe_u32 s69, s42, 0x5000a
s_mul_i32 s69, s69, 81920
s_add_u32 s69, s69, 20480
s_add_u32 m0, s57, 12288
s_add_u32 s69, s69, s59
buffer_load_dwordx4 v17, s[28:31], s69 offen  lds
s_add_u32 m0, s57, 14336
s_add_u32 s69, s69, 20480
buffer_load_dwordx4 v17, s[28:31], s69 offen  lds
s_add_u32 m0, s57, 16384
s_add_u32 s69, s69, 20480
buffer_load_dwordx4 v17, s[28:31], s69 offen  lds
s_bfe_u32 s69, s42, 0x5000a
s_lshl_b32 s69, s69, 11
s_add_u32 m0, s57, 18432
s_add_u32 s69, s69, s66
buffer_load_dwordx4 v4, s[32:35], s69 offen sc1 lds
s_bfe_u32 s69, s42, 0x5000f
s_mul_i32 s69, s69, 81920
s_add_u32 m0, s57, 153600
s_add_u32 s69, s69, s59
buffer_load_dwordx4 v17, s[28:31], s69 offen  lds
s_add_u32 m0, s57, 155648
s_add_u32 s69, s69, 20480
buffer_load_dwordx4 v17, s[28:31], s69 offen  lds
s_add_u32 m0, s57, 157696
s_add_u32 s69, s69, 20480
buffer_load_dwordx4 v17, s[28:31], s69 offen  lds
s_waitcnt vmcnt(43)
s_barrier
s_bfe_u32 s69, s42, 0x5000f
s_mul_i32 s69, s69, 81920
s_add_u32 s69, s69, 61440
s_add_u32 m0, s57, 159744
s_add_u32 s69, s69, s59
buffer_load_dwordx4 v17, s[28:31], s69 offen  lds
s_bfe_u32 s69, s42, 0x5000f
s_lshl_b32 s69, s69, 11
s_add_u32 m0, s57, 161792
s_add_u32 s69, s69, s66
buffer_load_dwordx4 v4, s[32:35], s69 offen sc1 lds
s_bfe_u32 s69, s42, 0x50014
s_mul_i32 s69, s69, 81920
s_add_u32 m0, s57, 143360
s_add_u32 s69, s69, s59
buffer_load_dwordx4 v17, s[28:31], s69 offen  lds
s_add_u32 m0, s57, 145408
s_add_u32 s69, s69, 20480
buffer_load_dwordx4 v17, s[28:31], s69 offen  lds
s_add_u32 m0, s57, 147456
s_add_u32 s69, s69, 20480
buffer_load_dwordx4 v17, s[28:31], s69 offen  lds
s_add_u32 m0, s57, 149504
s_add_u32 s69, s69, 20480
buffer_load_dwordx4 v17, s[28:31], s69 offen  lds
s_bfe_u32 s69, s42, 0x50014
s_lshl_b32 s69, s69, 11
s_add_u32 m0, s57, 151552
s_add_u32 s69, s69, s66
buffer_load_dwordx4 v4, s[32:35], s69 offen sc1 lds
s_waitcnt vmcnt(40)
s_barrier
s_bfe_u32 s69, s42, 0x50019
s_mul_i32 s69, s69, 81920
s_add_u32 m0, s57, 133120
s_add_u32 s69, s69, s59
buffer_load_dwordx4 v17, s[28:31], s69 offen  lds
s_add_u32 m0, s57, 135168
s_add_u32 s69, s69, 20480
buffer_load_dwordx4 v17, s[28:31], s69 offen  lds
s_add_u32 m0, s57, 137216
s_add_u32 s69, s69, 20480
buffer_load_dwordx4 v17, s[28:31], s69 offen  lds
s_add_u32 m0, s57, 139264
s_add_u32 s69, s69, 20480
buffer_load_dwordx4 v17, s[28:31], s69 offen  lds
s_bfe_u32 s69, s42, 0x50019
s_lshl_b32 s69, s69, 11
s_add_u32 m0, s57, 141312
s_add_u32 s69, s69, s66
buffer_load_dwordx4 v4, s[32:35], s69 offen sc1 lds
s_bfe_u32 s69, s43, 0x50000
s_mul_i32 s69, s69, 81920
s_add_u32 m0, s57, 122880
s_add_u32 s69, s69, s59
buffer_load_dwordx4 v17, s[28:31], s69 offen  lds
s_add_u32 m0, s57, 124928
s_add_u32 s69, s69, 20480
buffer_load_dwordx4 v17, s[28:31], s69 offen  lds
s_waitcnt vmcnt(37)
s_barrier
s_bfe_u32 s69, s43, 0x50000
s_mul_i32 s69, s69, 81920
s_add_u32 s69, s69, 40960
s_add_u32 m0, s57, 126976
s_add_u32 s69, s69, s59
buffer_load_dwordx4 v17, s[28:31], s69 offen  lds
s_add_u32 m0, s57, 129024
s_add_u32 s69, s69, 20480
buffer_load_dwordx4 v17, s[28:31], s69 offen  lds
s_bfe_u32 s69, s43, 0x50000
s_lshl_b32 s69, s69, 11
s_add_u32 m0, s57, 131072
s_add_u32 s69, s69, s66
buffer_load_dwordx4 v4, s[32:35], s69 offen sc1 lds
s_bfe_u32 s69, s43, 0x50005
s_mul_i32 s69, s69, 81920
s_add_u32 m0, s57, 112640
s_add_u32 s69, s69, s59
buffer_load_dwordx4 v17, s[28:31], s69 offen  lds
s_add_u32 m0, s57, 114688
s_add_u32 s69, s69, 20480
buffer_load_dwordx4 v17, s[28:31], s69 offen  lds
s_add_u32 m0, s57, 116736
s_add_u32 s69, s69, 20480
buffer_load_dwordx4 v17, s[28:31], s69 offen  lds
s_add_u32 m0, s57, 118784
s_add_u32 s69, s69, 20480
buffer_load_dwordx4 v17, s[28:31], s69 offen  lds
s_waitcnt vmcnt(34)
s_barrier
s_bfe_u32 s69, s43, 0x50005
s_lshl_b32 s69, s69, 11
s_add_u32 m0, s57, 120832
s_add_u32 s69, s69, s66
buffer_load_dwordx4 v4, s[32:35], s69 offen sc1 lds
s_bfe_u32 s69, s43, 0x5000a
s_mul_i32 s69, s69, 81920
s_add_u32 m0, s57, 102400
s_add_u32 s69, s69, s59
buffer_load_dwordx4 v17, s[28:31], s69 offen  lds
s_add_u32 m0, s57, 104448
s_add_u32 s69, s69, 20480
buffer_load_dwordx4 v17, s[28:31], s69 offen  lds
s_add_u32 m0, s57, 106496
s_add_u32 s69, s69, 20480
buffer_load_dwordx4 v17, s[28:31], s69 offen  lds
s_add_u32 m0, s57, 108544
s_add_u32 s69, s69, 20480
buffer_load_dwordx4 v17, s[28:31], s69 offen  lds
s_bfe_u32 s69, s43, 0x5000a
s_lshl_b32 s69, s69, 11
s_add_u32 m0, s57, 110592
s_add_u32 s69, s69, s66
buffer_load_dwordx4 v4, s[32:35], s69 offen sc1 lds
s_bfe_u32 s69, s43, 0x5000f
s_mul_i32 s69, s69, 81920
s_add_u32 m0, s57, 92160
s_add_u32 s69, s69, s59
buffer_load_dwordx4 v17, s[28:31], s69 offen  lds
s_waitcnt vmcnt(31)
s_barrier
s_bfe_u32 s69, s43, 0x5000f
s_mul_i32 s69, s69, 81920
s_add_u32 s69, s69, 20480
s_add_u32 m0, s57, 94208
s_add_u32 s69, s69, s59
buffer_load_dwordx4 v17, s[28:31], s69 offen  lds
s_add_u32 m0, s57, 96256
s_add_u32 s69, s69, 20480
buffer_load_dwordx4 v17, s[28:31], s69 offen  lds
s_add_u32 m0, s57, 98304
s_add_u32 s69, s69, 20480
buffer_load_dwordx4 v17, s[28:31], s69 offen  lds
s_bfe_u32 s69, s43, 0x5000f
s_lshl_b32 s69, s69, 11
s_add_u32 m0, s57, 100352
s_add_u32 s69, s69, s66
buffer_load_dwordx4 v4, s[32:35], s69 offen sc1 lds
s_bfe_u32 s69, s43, 0x50014
s_mul_i32 s69, s69, 81920
s_add_u32 m0, s57, 81920
s_add_u32 s69, s69, s59
buffer_load_dwordx4 v17, s[28:31], s69 offen  lds
s_add_u32 m0, s57, 83968
s_add_u32 s69, s69, 20480
buffer_load_dwordx4 v17, s[28:31], s69 offen  lds
s_add_u32 m0, s57, 86016
s_add_u32 s69, s69, 20480
buffer_load_dwordx4 v17, s[28:31], s69 offen  lds
s_waitcnt vmcnt(28)
s_barrier
s_bfe_u32 s69, s43, 0x50014
s_mul_i32 s69, s69, 81920
s_add_u32 s69, s69, 61440
s_add_u32 m0, s57, 88064
s_add_u32 s69, s69, s59
buffer_load_dwordx4 v17, s[28:31], s69 offen  lds
s_bfe_u32 s69, s43, 0x50014
s_lshl_b32 s69, s69, 11
s_add_u32 m0, s57, 90112
s_add_u32 s69, s69, s66
buffer_load_dwordx4 v4, s[32:35], s69 offen sc1 lds
s_bfe_u32 s69, s43, 0x50019
s_mul_i32 s69, s69, 81920
s_add_u32 m0, s57, 71680
s_add_u32 s69, s69, s59
buffer_load_dwordx4 v17, s[28:31], s69 offen  lds
s_add_u32 m0, s57, 73728
s_add_u32 s69, s69, 20480
buffer_load_dwordx4 v17, s[28:31], s69 offen  lds
s_add_u32 m0, s57, 75776
s_add_u32 s69, s69, 20480
buffer_load_dwordx4 v17, s[28:31], s69 offen  lds
s_add_u32 m0, s57, 77824
s_add_u32 s69, s69, 20480
buffer_load_dwordx4 v17, s[28:31], s69 offen  lds
s_bfe_u32 s69, s43, 0x50019
s_lshl_b32 s69, s69, 11
s_add_u32 m0, s57, 79872
s_add_u32 s69, s69, s66
buffer_load_dwordx4 v4, s[32:35], s69 offen sc1 lds
s_waitcnt vmcnt(25)
s_barrier
s_waitcnt vmcnt(15)
s_barrier
s_waitcnt vmcnt(0)
s_barrier
L_end:
s_endpgm
.p2align 12
.p2align 6
L_compute:
s_load_dwordx2 s[32:33], s[0:1], 56
s_load_dwordx2 s[36:37], s[0:1], 16
s_load_dwordx2 s[40:41], s[0:1], 32
s_load_dwordx2 s[44:45], s[0:1], 40
s_getpc_b64 s[64:65]
L_pc:
s_add_u32 s66, s64, L_table-L_pc
s_addc_u32 s67, s65, 0
s_lshl_b32 s68, s49, 3
s_add_u32 s68, s68, s54
s_lshl_b32 s68, s68, 4
s_and_b32 s56, s50, 1
s_lshr_b32 s57, s50, 1
v_lshrrev_b32 v14, 5, v0
v_and_b32 v15, 31, v0
s_mul_i32 s58, s49, 384
s_lshl_b32 s59, s57, 6
s_add_u32 s58, s58, s59
v_lshl_add_u32 v29, v15, 1, s58
v_lshl_add_u32 v29, v14, 16, v29
s_mov_b32 s34, 9437184
s_mov_b32 s35, 0x20000
s_mov_b32 s38, 3072
s_mov_b32 s39, 0x20000
s_mov_b32 s42, 1280
s_mov_b32 s43, 0x20000
s_mov_b32 s46, 2621440
s_mov_b32 s47, 0x20000
s_lshl_b32 s63, s48, 2
s_add_u32 s63, s63, s50
s_mul_i32 s63, s63, 768
s_add_u32 s63, s63, 8265728
s_waitcnt lgkmcnt(0)
s_load_dwordx4 s[72:75], s[66:67], s68
s_mov_b32 s58, 8257536
s_load_dword s51, s[32:33], s58
buffer_load_ushort v8, v29, s[36:39], 0 offen
buffer_load_ushort v6, v29, s[36:39], 0 offen offset:128
buffer_load_ushort v7, v29, s[36:39], 0 offen offset:256
s_lshl_b32 s58, s55, 2
s_add_u32 s58, s58, s50
s_lshl_b32 s58, s58, 2
s_lshl_b32 s59, s48, 6
s_add_u32 s58, s58, s59
s_mul_i32 s58, s58, 1280
s_and_b32 s59, s49, 4
s_lshl_b32 s59, s59, 5
s_add_u32 s58, s58, s59
s_add_u32 s58, s58, 1024
s_add_u32 s4, s44, s58
s_addc_u32 s5, s45, 0
s_load_dword s8, s[4:5], 0 glc
s_load_dword s9, s[4:5], 64 glc
s_load_dword s10, s[4:5], 1280 glc
s_load_dword s11, s[4:5], 1344 glc
s_load_dword s12, s[4:5], 2560 glc
s_load_dword s13, s[4:5], 2624 glc
s_load_dword s14, s[4:5], 3840 glc
s_load_dword s15, s[4:5], 3904 glc
s_lshl_b32 s58, s49, 7
v_lshlrev_b32 v30, 1, v0
buffer_load_ushort v9, v30, s[40:43], s58 offen
s_lshl_b32 s58, s49, 5
v_lshrrev_b32 v31, 4, v0
v_lshl_add_u32 v30, v31, 16, v30
buffer_load_ushort v31, v30, s[40:43], s58 offen offset:1024
s_lshl_b32 s59, s49, 2
s_add_u32 s59, s59, s63
s_add_u32 s70, s32, s59
s_addc_u32 s71, s33, 0
s_add_u32 s88, s32, s63
s_addc_u32 s89, s33, 0
s_lshl_b32 s58, s56, 12
s_lshl_b32 s59, s57, 11
s_add_u32 s58, s58, s59
v_and_b32 v15, 15, v0
v_lshl_add_u32 v16, v15, 7, s58
v_lshrrev_b32 v14, 4, v0
v_bfe_u32 v17, v0, 1, 3
v_xor_b32 v17, v14, v17
v_lshl_add_u32 v16, v17, 4, v16
v_xor_b32 v17, 0x800, v16
v_xor_b32 v18, 64, v16
v_xor_b32 v19, 64, v17
v_add_u32 v20, 0x10000, v16
v_add_u32 v21, 0x10000, v17
v_add_u32 v22, 0x10000, v18
v_add_u32 v23, 0x10000, v19
v_add_u32 v24, 0x20000, v16
v_add_u32 v25, 0x20000, v17
v_add_u32 v26, 0x20000, v18
v_add_u32 v27, 0x20000, v19
v_lshlrev_b32 v1, 10, v14
v_bfe_u32 v15, v0, 2, 2
v_lshl_add_u32 v1, v15, 7, v1
v_bfe_u32 v15, v0, 3, 2
s_lshl_b32 s59, s57, 1
v_xor_b32 v15, s59, v15
v_lshl_add_u32 v1, v15, 5, v1
v_and_b32 v15, 3, v0
v_lshl_add_u32 v1, v15, 3, v1
v_xor_b32 v2, 32, v1
v_add_u32 v3, 0x10000, v1
v_add_u32 v13, 0x10000, v2
v_cmp_gt_u32 vcc, 16, v0
v_mov_b32 v10, 0x3f80
v_mov_b32 v11, 0
v_cndmask_b32 v10, v11, v10, vcc
s_mul_i32 s60, s48, 196608
s_lshl_b32 s58, s56, 11
s_mul_i32 s59, s57, 5120
s_add_u32 s60, s60, s58
s_add_u32 s60, s60, s59
v_lshl_add_u32 v14, v0, 4, s60
v_xor_b32 v15, 0x400, v14
s_mul_i32 s61, s49, 24576
v_mov_b32 v5, 0xbdd2d3e8
s_mov_b32 s76, 0xc0135761
s_mov_b32 s77, 0xc0135761
v_mov_b32 v12, 0
s_waitcnt lgkmcnt(0)
s_cmp_lg_u32 s50, 0
s_cbranch_scc1 L_nw0
s_call_b64 s[66:67], L_stub0
L_nw0:
s_cmp_lg_u32 s50, 1
s_cbranch_scc1 L_nw1
s_call_b64 s[66:67], L_stub1
L_nw1:
s_cmp_lg_u32 s50, 2
s_cbranch_scc1 L_nw2
s_call_b64 s[66:67], L_stub2
L_nw2:
s_cmp_lg_u32 s50, 3
s_cbranch_scc1 L_nw3
s_call_b64 s[66:67], L_stub3
L_nw3:
s_cmp_lg_u32 s50, 0
s_cbranch_scc1 L_nw4
s_call_b64 s[66:67], L_stub4
L_nw4:
s_waitcnt lgkmcnt(0)
s_bfe_u32 s6, s72, 0x5000a
s_lshl_b32 s6, s6, 13
s_bfe_u32 s7, s72, 0x5000f
s_lshl_b32 s7, s7, 13
s_bfe_u32 s8, s72, 0x50014
s_lshl_b32 s8, s8, 13
s_bfe_u32 s9, s72, 0x50019
s_lshl_b32 s9, s9, 13
s_bfe_u32 s10, s73, 0x50000
s_lshl_b32 s10, s10, 13
s_bfe_u32 s11, s73, 0x50005
s_lshl_b32 s11, s11, 13
s_bfe_u32 s12, s73, 0x5000a
s_lshl_b32 s12, s12, 13
s_bfe_u32 s13, s73, 0x5000f
s_lshl_b32 s13, s13, 13
s_bfe_u32 s14, s73, 0x50014
s_lshl_b32 s14, s14, 13
s_bfe_u32 s15, s73, 0x50019
s_lshl_b32 s15, s15, 13
s_bfe_u32 s16, s74, 0x50000
s_lshl_b32 s16, s16, 13
s_bfe_u32 s17, s74, 0x50005
s_lshl_b32 s17, s17, 13
s_bfe_u32 s18, s74, 0x5000a
s_lshl_b32 s18, s18, 13
s_bfe_u32 s19, s74, 0x5000f
s_lshl_b32 s19, s19, 13
s_bfe_u32 s20, s74, 0x50014
s_lshl_b32 s20, s20, 13
s_bfe_u32 s21, s74, 0x50019
s_lshl_b32 s21, s21, 13
s_bfe_u32 s22, s75, 0x50000
s_lshl_b32 s22, s22, 13
s_bfe_u32 s23, s75, 0x50005
s_lshl_b32 s23, s23, 13
s_bfe_u32 s24, s75, 0x5000a
s_lshl_b32 s24, s24, 13
s_bfe_u32 s25, s75, 0x5000f
s_lshl_b32 s25, s25, 13
s_bfe_u32 s26, s75, 0x50014
s_lshl_b32 s26, s26, 13
s_bfe_u32 s27, s75, 0x50019
s_lshl_b32 s27, s27, 13
s_barrier
ds_read_b128 v[96:99], v16 offset:0
ds_read_b64_tr_b16 v[32:33], v1 offset:8192
ds_read_b64_tr_b16 v[34:35], v1 offset:8704
ds_read_b128 v[100:103], v17 offset:0
ds_read_b64_tr_b16 v[36:37], v2 offset:8192
ds_read_b64_tr_b16 v[38:39], v2 offset:8704
ds_read_b128 v[104:107], v18 offset:0
ds_read_b64_tr_b16 v[40:41], v2 offset:12288
ds_read_b64_tr_b16 v[42:43], v2 offset:12800
ds_read_b128 v[108:111], v19 offset:0
ds_read_b64_tr_b16 v[44:45], v1 offset:12288
ds_read_b64_tr_b16 v[46:47], v1 offset:12800
s_waitcnt lgkmcnt(0)
s_barrier
v_mfma_f32_16x16x32_bf16 v[64:67], v[32:35], v[96:99], 0
ds_read_b128 v[112:115], v16 offset:16384
ds_read_b64_tr_b16 v[48:49], v1 offset:24576
ds_read_b64_tr_b16 v[50:51], v1 offset:25088
v_mfma_f32_16x16x32_bf16 v[72:75], v[32:35], v[100:103], 0
s_waitcnt vmcnt(0)
v_lshl_or_b32 v9, v31, 16, v9
s_mul_i32 s51, s51, 1664525
s_add_u32 s51, s51, 1013904223
s_mov_b32 s78, s51
s_mov_b32 s79, s51
v_mfma_f32_16x16x32_bf16 v[64:67], v[8:11], v[10:13], v[64:67]
v_mfma_f32_16x16x32_bf16 v[72:75], v[8:11], v[10:13], v[72:75]
v_xor_b32 v10, 0x3f80, v10
ds_read_b128 v[116:119], v17 offset:16384
ds_read_b64_tr_b16 v[52:53], v2 offset:24576
ds_read_b64_tr_b16 v[54:55], v2 offset:25088
v_mfma_f32_16x16x32_bf16 v[76:79], v[36:39], v[100:103], 0
ds_read_b128 v[120:123], v18 offset:16384
ds_read_b64_tr_b16 v[56:57], v2 offset:28672
ds_read_b64_tr_b16 v[58:59], v2 offset:29184
v_mfma_f32_16x16x32_bf16 v[68:71], v[36:39], v[96:99], 0
v_mfma_f32_16x16x32_bf16 v[68:71], v[8:11], v[10:13], v[68:71]
v_mfma_f32_16x16x32_bf16 v[76:79], v[8:11], v[10:13], v[76:79]
v_xor_b32 v10, 0x3f80, v10
ds_read_b128 v[124:127], v19 offset:16384
ds_read_b64_tr_b16 v[60:61], v1 offset:28672
ds_read_b64_tr_b16 v[62:63], v1 offset:29184
v_mfma_f32_16x16x32_bf16 v[68:71], v[40:43], v[104:107], v[68:71]
v_mfma_f32_16x16x32_bf16 v[76:79], v[40:43], v[108:111], v[76:79]
v_mfma_f32_16x16x32_bf16 v[72:75], v[44:47], v[108:111], v[72:75]
v_mfma_f32_16x16x32_bf16 v[64:67], v[44:47], v[104:107], v[64:67]
v_mov_b32 v8, v6
s_waitcnt lgkmcnt(0)
s_barrier
v_mfma_f32_16x16x32_bf16 v[64:67], v[48:51], v[112:115], v[64:67]
ds_read_b128 v[128:131], v16 offset:32768
ds_read_b64_tr_b16 v[32:33], v1 offset:40960
ds_read_b64_tr_b16 v[34:35], v1 offset:41472
v_mfma_f32_16x16x32_bf16 v[72:75], v[48:51], v[116:119], v[72:75]
ds_read_b128 v[132:135], v17 offset:32768
ds_read_b64_tr_b16 v[36:37], v2 offset:40960
ds_read_b64_tr_b16 v[38:39], v2 offset:41472
v_mfma_f32_16x16x32_bf16 v[76:79], v[52:55], v[116:119], v[76:79]
ds_read_b128 v[136:139], v18 offset:32768
ds_read_b64_tr_b16 v[40:41], v2 offset:45056
ds_read_b64_tr_b16 v[42:43], v2 offset:45568
v_mfma_f32_16x16x32_bf16 v[68:71], v[52:55], v[112:115], v[68:71]
ds_read_b128 v[140:143], v19 offset:32768
ds_read_b64_tr_b16 v[44:45], v1 offset:45056
ds_read_b64_tr_b16 v[46:47], v1 offset:45568
v_mfma_f32_16x16x32_bf16 v[68:71], v[56:59], v[120:123], v[68:71]
v_mfma_f32_16x16x32_bf16 v[76:79], v[56:59], v[124:127], v[76:79]
v_mfma_f32_16x16x32_bf16 v[72:75], v[60:63], v[124:127], v[72:75]
v_mfma_f32_16x16x32_bf16 v[64:67], v[60:63], v[120:123], v[64:67]
s_waitcnt lgkmcnt(0)
s_barrier
v_mfma_f32_16x16x32_bf16 v[64:67], v[32:35], v[128:131], v[64:67]
ds_read_b128 v[144:147], v16 offset:49152
ds_read_b64_tr_b16 v[48:49], v1 offset:57344
ds_read_b64_tr_b16 v[50:51], v1 offset:57856
v_mfma_f32_16x16x32_bf16 v[72:75], v[32:35], v[132:135], v[72:75]
ds_read_b128 v[148:151], v17 offset:49152
ds_read_b64_tr_b16 v[52:53], v2 offset:57344
ds_read_b64_tr_b16 v[54:55], v2 offset:57856
v_mfma_f32_16x16x32_bf16 v[76:79], v[36:39], v[132:135], v[76:79]
ds_read_b128 v[152:155], v18 offset:49152
ds_read_b64_tr_b16 v[56:57], v2 offset:61440
ds_read_b64_tr_b16 v[58:59], v2 offset:61952
v_mfma_f32_16x16x32_bf16 v[68:71], v[36:39], v[128:131], v[68:71]
ds_read_b128 v[156:159], v19 offset:49152
ds_read_b64_tr_b16 v[60:61], v1 offset:61440
ds_read_b64_tr_b16 v[62:63], v1 offset:61952
v_mfma_f32_16x16x32_bf16 v[68:71], v[40:43], v[136:139], v[68:71]
v_mfma_f32_16x16x32_bf16 v[76:79], v[40:43], v[140:143], v[76:79]
v_mfma_f32_16x16x32_bf16 v[72:75], v[44:47], v[140:143], v[72:75]
v_mfma_f32_16x16x32_bf16 v[64:67], v[44:47], v[136:139], v[64:67]
s_waitcnt lgkmcnt(0)
s_barrier
v_mfma_f32_16x16x32_bf16 v[64:67], v[48:51], v[144:147], v[64:67]
ds_read_b128 v[160:163], v16 offset:0
ds_read_b64_tr_b16 v[32:33], v1 offset:8192
ds_read_b64_tr_b16 v[34:35], v1 offset:8704
v_mfma_f32_16x16x32_bf16 v[72:75], v[48:51], v[148:151], v[72:75]
ds_read_b128 v[164:167], v17 offset:0
ds_read_b64_tr_b16 v[36:37], v2 offset:8192
ds_read_b64_tr_b16 v[38:39], v2 offset:8704
v_mfma_f32_16x16x32_bf16 v[76:79], v[52:55], v[148:151], v[76:79]
ds_read_b128 v[168:171], v18 offset:0
ds_read_b64_tr_b16 v[40:41], v2 offset:12288
ds_read_b64_tr_b16 v[42:43], v2 offset:12800
v_mfma_f32_16x16x32_bf16 v[68:71], v[52:55], v[144:147], v[68:71]
ds_read_b128 v[172:175], v19 offset:0
ds_read_b64_tr_b16 v[44:45], v1 offset:12288
ds_read_b64_tr_b16 v[46:47], v1 offset:12800
v_mfma_f32_16x16x32_bf16 v[68:71], v[56:59], v[152:155], v[68:71]
v_mfma_f32_16x16x32_bf16 v[76:79], v[56:59], v[156:159], v[76:79]
v_mfma_f32_16x16x32_bf16 v[72:75], v[60:63], v[156:159], v[72:75]
v_mfma_f32_16x16x32_bf16 v[64:67], v[60:63], v[152:155], v[64:67]
s_waitcnt lgkmcnt(0)
s_barrier
v_mfma_f32_16x16x32_bf16 v[64:67], v[32:35], v[160:163], v[64:67]
ds_read_b128 v[176:179], v16 offset:16384
ds_read_b64_tr_b16 v[48:49], v1 offset:24576
ds_read_b64_tr_b16 v[50:51], v1 offset:25088
v_mfma_f32_16x16x32_bf16 v[72:75], v[32:35], v[164:167], v[72:75]
ds_read_b128 v[180:183], v17 offset:16384
ds_read_b64_tr_b16 v[52:53], v2 offset:24576
ds_read_b64_tr_b16 v[54:55], v2 offset:25088
v_mfma_f32_16x16x32_bf16 v[76:79], v[36:39], v[164:167], v[76:79]
ds_read_b128 v[184:187], v18 offset:16384
ds_read_b64_tr_b16 v[56:57], v2 offset:28672
ds_read_b64_tr_b16 v[58:59], v2 offset:29184
v_mfma_f32_16x16x32_bf16 v[68:71], v[36:39], v[160:163], v[68:71]
ds_read_b128 v[188:191], v19 offset:16384
ds_read_b64_tr_b16 v[60:61], v1 offset:28672
ds_read_b64_tr_b16 v[62:63], v1 offset:29184
v_mfma_f32_16x16x32_bf16 v[68:71], v[40:43], v[168:171], v[68:71]
v_mfma_f32_16x16x32_bf16 v[76:79], v[40:43], v[172:175], v[76:79]
v_mfma_f32_16x16x32_bf16 v[72:75], v[44:47], v[172:175], v[72:75]
v_mfma_f32_16x16x32_bf16 v[64:67], v[44:47], v[168:171], v[64:67]
s_waitcnt lgkmcnt(0)
s_barrier
v_mfma_f32_16x16x32_bf16 v[64:67], v[48:51], v[176:179], v[64:67]
ds_read_b128 v[192:195], v16 offset:32768
ds_read_b64_tr_b16 v[32:33], v1 offset:40960
ds_read_b64_tr_b16 v[34:35], v1 offset:41472
v_mfma_f32_16x16x32_bf16 v[72:75], v[48:51], v[180:183], v[72:75]
ds_read_b128 v[196:199], v17 offset:32768
ds_read_b64_tr_b16 v[36:37], v2 offset:40960
ds_read_b64_tr_b16 v[38:39], v2 offset:41472
v_mfma_f32_16x16x32_bf16 v[76:79], v[52:55], v[180:183], v[76:79]
ds_read_b128 v[200:203], v18 offset:32768
ds_read_b64_tr_b16 v[40:41], v2 offset:45056
ds_read_b64_tr_b16 v[42:43], v2 offset:45568
v_mfma_f32_16x16x32_bf16 v[68:71], v[52:55], v[176:179], v[68:71]
ds_read_b128 v[204:207], v19 offset:32768
ds_read_b64_tr_b16 v[44:45], v1 offset:45056
ds_read_b64_tr_b16 v[46:47], v1 offset:45568
v_mfma_f32_16x16x32_bf16 v[68:71], v[56:59], v[184:187], v[68:71]
v_mfma_f32_16x16x32_bf16 v[76:79], v[56:59], v[188:191], v[76:79]
v_mfma_f32_16x16x32_bf16 v[72:75], v[60:63], v[188:191], v[72:75]
v_mfma_f32_16x16x32_bf16 v[64:67], v[60:63], v[184:187], v[64:67]
s_waitcnt lgkmcnt(0)
s_barrier
v_mfma_f32_16x16x32_bf16 v[64:67], v[32:35], v[192:195], v[64:67]
ds_read_b128 v[208:211], v16 offset:49152
ds_read_b64_tr_b16 v[48:49], v1 offset:57344
ds_read_b64_tr_b16 v[50:51], v1 offset:57856
v_mfma_f32_16x16x32_bf16 v[72:75], v[32:35], v[196:199], v[72:75]
ds_read_b128 v[212:215], v17 offset:49152
ds_read_b64_tr_b16 v[52:53], v2 offset:57344
ds_read_b64_tr_b16 v[54:55], v2 offset:57856
v_mfma_f32_16x16x32_bf16 v[76:79], v[36:39], v[196:199], v[76:79]
ds_read_b128 v[216:219], v18 offset:49152
ds_read_b64_tr_b16 v[56:57], v2 offset:61440
ds_read_b64_tr_b16 v[58:59], v2 offset:61952
v_mfma_f32_16x16x32_bf16 v[68:71], v[36:39], v[192:195], v[68:71]
ds_read_b128 v[220:223], v19 offset:49152
ds_read_b64_tr_b16 v[60:61], v1 offset:61440
ds_read_b64_tr_b16 v[62:63], v1 offset:61952
v_mfma_f32_16x16x32_bf16 v[68:71], v[40:43], v[200:203], v[68:71]
v_mfma_f32_16x16x32_bf16 v[76:79], v[40:43], v[204:207], v[76:79]
v_mfma_f32_16x16x32_bf16 v[72:75], v[44:47], v[204:207], v[72:75]
v_mfma_f32_16x16x32_bf16 v[64:67], v[44:47], v[200:203], v[64:67]
s_waitcnt lgkmcnt(0)
s_barrier
v_mfma_f32_16x16x32_bf16 v[64:67], v[48:51], v[208:211], v[64:67]
ds_read_b128 v[224:227], v16 offset:0
ds_read_b64_tr_b16 v[32:33], v1 offset:8192
ds_read_b64_tr_b16 v[34:35], v1 offset:8704
v_mfma_f32_16x16x32_bf16 v[72:75], v[48:51], v[212:215], v[72:75]
ds_read_b128 v[228:231], v17 offset:0
ds_read_b64_tr_b16 v[36:37], v2 offset:8192
ds_read_b64_tr_b16 v[38:39], v2 offset:8704
v_mfma_f32_16x16x32_bf16 v[76:79], v[52:55], v[212:215], v[76:79]
ds_read_b128 v[232:235], v18 offset:0
ds_read_b64_tr_b16 v[40:41], v2 offset:12288
ds_read_b64_tr_b16 v[42:43], v2 offset:12800
v_mfma_f32_16x16x32_bf16 v[68:71], v[52:55], v[208:211], v[68:71]
ds_read_b128 v[236:239], v19 offset:0
ds_read_b64_tr_b16 v[44:45], v1 offset:12288
ds_read_b64_tr_b16 v[46:47], v1 offset:12800
v_mfma_f32_16x16x32_bf16 v[68:71], v[56:59], v[216:219], v[68:71]
v_mfma_f32_16x16x32_bf16 v[76:79], v[56:59], v[220:223], v[76:79]
v_mfma_f32_16x16x32_bf16 v[72:75], v[60:63], v[220:223], v[72:75]
v_mfma_f32_16x16x32_bf16 v[64:67], v[60:63], v[216:219], v[64:67]
s_waitcnt lgkmcnt(0)
s_barrier
v_mfma_f32_16x16x32_bf16 v[64:67], v[32:35], v[224:227], v[64:67]
ds_read_b128 v[240:243], v16 offset:16384
ds_read_b64_tr_b16 v[48:49], v1 offset:24576
ds_read_b64_tr_b16 v[50:51], v1 offset:25088
v_mfma_f32_16x16x32_bf16 v[72:75], v[32:35], v[228:231], v[72:75]
ds_read_b128 v[244:247], v17 offset:16384
ds_read_b64_tr_b16 v[52:53], v2 offset:24576
ds_read_b64_tr_b16 v[54:55], v2 offset:25088
v_mfma_f32_16x16x32_bf16 v[76:79], v[36:39], v[228:231], v[76:79]
ds_read_b128 v[248:251], v18 offset:16384
ds_read_b64_tr_b16 v[56:57], v2 offset:28672
ds_read_b64_tr_b16 v[58:59], v2 offset:29184
v_mfma_f32_16x16x32_bf16 v[68:71], v[36:39], v[224:227], v[68:71]
ds_read_b128 v[252:255], v19 offset:16384
ds_read_b64_tr_b16 v[60:61], v1 offset:28672
ds_read_b64_tr_b16 v[62:63], v1 offset:29184
v_mfma_f32_16x16x32_bf16 v[68:71], v[40:43], v[232:235], v[68:71]
v_mfma_f32_16x16x32_bf16 v[76:79], v[40:43], v[236:239], v[76:79]
v_mfma_f32_16x16x32_bf16 v[72:75], v[44:47], v[236:239], v[72:75]
v_mfma_f32_16x16x32_bf16 v[64:67], v[44:47], v[232:235], v[64:67]
s_waitcnt lgkmcnt(0)
s_barrier
v_mfma_f32_16x16x32_bf16 v[64:67], v[48:51], v[240:243], v[64:67]
ds_read_b64_tr_b16 v[32:33], v1 offset:32768
ds_read_b64_tr_b16 v[34:35], v1 offset:33280
v_mfma_f32_16x16x32_bf16 v[72:75], v[48:51], v[244:247], v[72:75]
ds_read_b64_tr_b16 v[36:37], v2 offset:32768
ds_read_b64_tr_b16 v[38:39], v2 offset:33280
v_mfma_f32_16x16x32_bf16 v[76:79], v[52:55], v[244:247], v[76:79]
ds_read_b64_tr_b16 v[40:41], v2 offset:36864
ds_read_b64_tr_b16 v[42:43], v2 offset:37376
v_mfma_f32_16x16x32_bf16 v[68:71], v[52:55], v[240:243], v[68:71]
ds_read_b64_tr_b16 v[44:45], v1 offset:36864
ds_read_b64_tr_b16 v[46:47], v1 offset:37376
v_mfma_f32_16x16x32_bf16 v[68:71], v[56:59], v[248:251], v[68:71]
ds_read_b64_tr_b16 v[48:49], v1 offset:40960
ds_read_b64_tr_b16 v[50:51], v1 offset:41472
v_mfma_f32_16x16x32_bf16 v[76:79], v[56:59], v[252:255], v[76:79]
ds_read_b64_tr_b16 v[52:53], v2 offset:40960
ds_read_b64_tr_b16 v[54:55], v2 offset:41472
v_mfma_f32_16x16x32_bf16 v[72:75], v[60:63], v[252:255], v[72:75]
ds_read_b64_tr_b16 v[56:57], v2 offset:45056
ds_read_b64_tr_b16 v[58:59], v2 offset:45568
v_mfma_f32_16x16x32_bf16 v[64:67], v[60:63], v[248:251], v[64:67]
ds_read_b64_tr_b16 v[60:61], v1 offset:45056
ds_read_b64_tr_b16 v[62:63], v1 offset:45568
s_waitcnt lgkmcnt(8)
v_mfma_f32_16x16x32_bf16 v[80:83], v[32:35], v[96:99], 0
v_mfma_f32_16x16x32_bf16 v[88:91], v[32:35], v[100:103], 0
v_mfma_f32_16x16x32_bf16 v[80:83], v[8:11], v[10:13], v[80:83]
v_mfma_f32_16x16x32_bf16 v[88:91], v[8:11], v[10:13], v[88:91]
v_xor_b32 v10, 0x3f80, v10
v_mfma_f32_16x16x32_bf16 v[92:95], v[36:39], v[100:103], 0
v_mfma_f32_16x16x32_bf16 v[84:87], v[36:39], v[96:99], 0
v_mfma_f32_16x16x32_bf16 v[84:87], v[8:11], v[10:13], v[84:87]
v_mfma_f32_16x16x32_bf16 v[92:95], v[8:11], v[10:13], v[92:95]
v_xor_b32 v10, 0x3f80, v10
v_pk_mul_f32 v[24:25], v[64:65], v[64:65]
v_pk_mul_f32 v[26:27], v[66:67], v[66:67]
v_pk_mul_f32 v[28:29], v[68:69], v[68:69]
v_pk_mul_f32 v[30:31], v[70:71], v[70:71]
v_pk_fma_f32 v[24:25], v[24:25], v[4:5], s[76:77] op_sel:[0,1,0] op_sel_hi:[1,1,1]
v_pk_fma_f32 v[26:27], v[26:27], v[4:5], s[76:77] op_sel:[0,1,0] op_sel_hi:[1,1,1]
v_pk_fma_f32 v[28:29], v[28:29], v[4:5], s[76:77] op_sel:[0,1,0] op_sel_hi:[1,1,1]
v_pk_fma_f32 v[30:31], v[30:31], v[4:5], s[76:77] op_sel:[0,1,0] op_sel_hi:[1,1,1]
v_pk_mul_f32 v[24:25], v[64:65], v[24:25]
v_pk_mul_f32 v[26:27], v[66:67], v[26:27]
v_pk_mul_f32 v[28:29], v[68:69], v[28:29]
v_pk_mul_f32 v[30:31], v[70:71], v[30:31]
v_exp_f32 v24, v24
v_exp_f32 v25, v25
v_exp_f32 v26, v26
v_exp_f32 v27, v27
v_exp_f32 v28, v28
v_exp_f32 v29, v29
v_exp_f32 v30, v30
v_exp_f32 v31, v31
v_pk_add_f32 v[24:25], v[24:25], 1.0 op_sel_hi:[1,0]
v_pk_add_f32 v[26:27], v[26:27], 1.0 op_sel_hi:[1,0]
v_pk_add_f32 v[28:29], v[28:29], 1.0 op_sel_hi:[1,0]
v_pk_add_f32 v[30:31], v[30:31], 1.0 op_sel_hi:[1,0]
v_rcp_f32 v24, v24
v_rcp_f32 v25, v25
v_rcp_f32 v26, v26
v_rcp_f32 v27, v27
v_rcp_f32 v28, v28
v_rcp_f32 v29, v29
v_rcp_f32 v30, v30
v_rcp_f32 v31, v31
v_pk_mul_f32 v[24:25], v[64:65], v[24:25]
v_pk_mul_f32 v[26:27], v[66:67], v[26:27]
v_pk_mul_f32 v[28:29], v[68:69], v[28:29]
v_pk_mul_f32 v[30:31], v[70:71], v[30:31]
v_cvt_pk_bf16_f32 v16, v24, v25
v_cvt_pk_bf16_f32 v17, v26, v27
v_cvt_pk_bf16_f32 v18, v28, v29
v_cvt_pk_bf16_f32 v19, v30, v31
buffer_store_dwordx4 v[16:19], v14, s[32:35], s61 offen sc1
v_pk_mul_f32 v[24:25], v[72:73], v[72:73]
v_pk_mul_f32 v[26:27], v[74:75], v[74:75]
v_pk_mul_f32 v[28:29], v[76:77], v[76:77]
v_pk_mul_f32 v[30:31], v[78:79], v[78:79]
v_pk_fma_f32 v[24:25], v[24:25], v[4:5], s[76:77] op_sel:[0,1,0] op_sel_hi:[1,1,1]
v_pk_fma_f32 v[26:27], v[26:27], v[4:5], s[76:77] op_sel:[0,1,0] op_sel_hi:[1,1,1]
v_pk_fma_f32 v[28:29], v[28:29], v[4:5], s[76:77] op_sel:[0,1,0] op_sel_hi:[1,1,1]
v_pk_fma_f32 v[30:31], v[30:31], v[4:5], s[76:77] op_sel:[0,1,0] op_sel_hi:[1,1,1]
v_pk_mul_f32 v[24:25], v[72:73], v[24:25]
v_pk_mul_f32 v[26:27], v[74:75], v[26:27]
v_pk_mul_f32 v[28:29], v[76:77], v[28:29]
v_pk_mul_f32 v[30:31], v[78:79], v[30:31]
v_exp_f32 v24, v24
v_exp_f32 v25, v25
v_exp_f32 v26, v26
v_exp_f32 v27, v27
v_exp_f32 v28, v28
v_exp_f32 v29, v29
v_exp_f32 v30, v30
v_exp_f32 v31, v31
v_pk_add_f32 v[24:25], v[24:25], 1.0 op_sel_hi:[1,0]
v_pk_add_f32 v[26:27], v[26:27], 1.0 op_sel_hi:[1,0]
v_pk_add_f32 v[28:29], v[28:29], 1.0 op_sel_hi:[1,0]
v_pk_add_f32 v[30:31], v[30:31], 1.0 op_sel_hi:[1,0]
v_rcp_f32 v24, v24
v_rcp_f32 v25, v25
v_rcp_f32 v26, v26
v_rcp_f32 v27, v27
v_rcp_f32 v28, v28
v_rcp_f32 v29, v29
v_rcp_f32 v30, v30
v_rcp_f32 v31, v31
v_pk_mul_f32 v[24:25], v[72:73], v[24:25]
v_pk_mul_f32 v[26:27], v[74:75], v[26:27]
v_pk_mul_f32 v[28:29], v[76:77], v[28:29]
v_pk_mul_f32 v[30:31], v[78:79], v[30:31]
v_cvt_pk_bf16_f32 v20, v24, v25
v_cvt_pk_bf16_f32 v21, v26, v27
v_cvt_pk_bf16_f32 v22, v28, v29
v_cvt_pk_bf16_f32 v23, v30, v31
buffer_store_dwordx4 v[20:23], v15, s[32:35], s61 offen sc1
v_mfma_f32_16x16x32_bf16 v[84:87], v[40:43], v[104:107], v[84:87]
v_mfma_f32_16x16x32_bf16 v[92:95], v[40:43], v[108:111], v[92:95]
v_mfma_f32_16x16x32_bf16 v[88:91], v[44:47], v[108:111], v[88:91]
v_mfma_f32_16x16x32_bf16 v[80:83], v[44:47], v[104:107], v[80:83]
v_mov_b32 v8, v7
s_waitcnt lgkmcnt(0)
s_barrier
v_mfma_f32_16x16x32_bf16 v[80:83], v[48:51], v[112:115], v[80:83]
ds_read_b64_tr_b16 v[32:33], v1 offset:49152
ds_read_b64_tr_b16 v[34:35], v1 offset:49664
v_mfma_f32_16x16x32_bf16 v[88:91], v[48:51], v[116:119], v[88:91]
ds_read_b64_tr_b16 v[36:37], v2 offset:49152
ds_read_b64_tr_b16 v[38:39], v2 offset:49664
v_mfma_f32_16x16x32_bf16 v[92:95], v[52:55], v[116:119], v[92:95]
ds_read_b64_tr_b16 v[40:41], v2 offset:53248
ds_read_b64_tr_b16 v[42:43], v2 offset:53760
v_mfma_f32_16x16x32_bf16 v[84:87], v[52:55], v[112:115], v[84:87]
ds_read_b64_tr_b16 v[44:45], v1 offset:53248
ds_read_b64_tr_b16 v[46:47], v1 offset:53760
v_mfma_f32_16x16x32_bf16 v[84:87], v[56:59], v[120:123], v[84:87]
ds_read_b64_tr_b16 v[48:49], v1 offset:57344
ds_read_b64_tr_b16 v[50:51], v1 offset:57856
v_mfma_f32_16x16x32_bf16 v[92:95], v[56:59], v[124:127], v[92:95]
ds_read_b64_tr_b16 v[52:53], v2 offset:57344
ds_read_b64_tr_b16 v[54:55], v2 offset:57856
v_mfma_f32_16x16x32_bf16 v[88:91], v[60:63], v[124:127], v[88:91]
ds_read_b64_tr_b16 v[56:57], v2 offset:61440
ds_read_b64_tr_b16 v[58:59], v2 offset:61952
v_mfma_f32_16x16x32_bf16 v[80:83], v[60:63], v[120:123], v[80:83]
ds_read_b64_tr_b16 v[60:61], v1 offset:61440
ds_read_b64_tr_b16 v[62:63], v1 offset:61952
s_waitcnt lgkmcnt(8)
v_mfma_f32_16x16x32_bf16 v[80:83], v[32:35], v[128:131], v[80:83]
v_mfma_f32_16x16x32_bf16 v[88:91], v[32:35], v[132:135], v[88:91]
v_mfma_f32_16x16x32_bf16 v[92:95], v[36:39], v[132:135], v[92:95]
v_mfma_f32_16x16x32_bf16 v[84:87], v[36:39], v[128:131], v[84:87]
v_mfma_f32_16x16x32_bf16 v[84:87], v[40:43], v[136:139], v[84:87]
v_mfma_f32_16x16x32_bf16 v[92:95], v[40:43], v[140:143], v[92:95]
v_mfma_f32_16x16x32_bf16 v[88:91], v[44:47], v[140:143], v[88:91]
v_mfma_f32_16x16x32_bf16 v[80:83], v[44:47], v[136:139], v[80:83]
s_waitcnt lgkmcnt(0)
s_branch L_pg2
.p2align 12
L_stub2:
s_setpc_b64 s[66:67]
s_nop 0
L_pg2:
s_barrier
v_mfma_f32_16x16x32_bf16 v[80:83], v[48:51], v[144:147], v[80:83]
ds_read_b64_tr_b16 v[32:33], v1 offset:0
ds_read_b64_tr_b16 v[34:35], v1 offset:512
v_mfma_f32_16x16x32_bf16 v[88:91], v[48:51], v[148:151], v[88:91]
ds_read_b64_tr_b16 v[36:37], v2 offset:0
ds_read_b64_tr_b16 v[38:39], v2 offset:512
v_mfma_f32_16x16x32_bf16 v[92:95], v[52:55], v[148:151], v[92:95]
ds_read_b64_tr_b16 v[40:41], v2 offset:4096
ds_read_b64_tr_b16 v[42:43], v2 offset:4608
v_mfma_f32_16x16x32_bf16 v[84:87], v[52:55], v[144:147], v[84:87]
ds_read_b64_tr_b16 v[44:45], v1 offset:4096
ds_read_b64_tr_b16 v[46:47], v1 offset:4608
v_mfma_f32_16x16x32_bf16 v[84:87], v[56:59], v[152:155], v[84:87]
ds_read_b64_tr_b16 v[48:49], v1 offset:8192
ds_read_b64_tr_b16 v[50:51], v1 offset:8704
v_mfma_f32_16x16x32_bf16 v[92:95], v[56:59], v[156:159], v[92:95]
ds_read_b64_tr_b16 v[52:53], v2 offset:8192
ds_read_b64_tr_b16 v[54:55], v2 offset:8704
v_mfma_f32_16x16x32_bf16 v[88:91], v[60:63], v[156:159], v[88:91]
ds_read_b64_tr_b16 v[56:57], v2 offset:12288
ds_read_b64_tr_b16 v[58:59], v2 offset:12800
v_mfma_f32_16x16x32_bf16 v[80:83], v[60:63], v[152:155], v[80:83]
ds_read_b64_tr_b16 v[60:61], v1 offset:12288
ds_read_b64_tr_b16 v[62:63], v1 offset:12800
s_waitcnt lgkmcnt(8)
v_mfma_f32_16x16x32_bf16 v[80:83], v[32:35], v[160:163], v[80:83]
v_mfma_f32_16x16x32_bf16 v[88:91], v[32:35], v[164:167], v[88:91]
v_mfma_f32_16x16x32_bf16 v[92:95], v[36:39], v[164:167], v[92:95]
v_mfma_f32_16x16x32_bf16 v[84:87], v[36:39], v[160:163], v[84:87]
v_mfma_f32_16x16x32_bf16 v[84:87], v[40:43], v[168:171], v[84:87]
v_mfma_f32_16x16x32_bf16 v[92:95], v[40:43], v[172:175], v[92:95]
v_mfma_f32_16x16x32_bf16 v[88:91], v[44:47], v[172:175], v[88:91]
v_mfma_f32_16x16x32_bf16 v[80:83], v[44:47], v[168:171], v[80:83]
s_waitcnt lgkmcnt(0)
s_barrier
v_mfma_f32_16x16x32_bf16 v[80:83], v[48:51], v[176:179], v[80:83]
ds_read_b64_tr_b16 v[32:33], v1 offset:16384
ds_read_b64_tr_b16 v[34:35], v1 offset:16896
v_mfma_f32_16x16x32_bf16 v[88:91], v[48:51], v[180:183], v[88:91]
ds_read_b64_tr_b16 v[36:37], v2 offset:16384
ds_read_b64_tr_b16 v[38:39], v2 offset:16896
v_mfma_f32_16x16x32_bf16 v[92:95], v[52:55], v[180:183], v[92:95]
ds_read_b64_tr_b16 v[40:41], v2 offset:20480
ds_read_b64_tr_b16 v[42:43], v2 offset:20992
v_mfma_f32_16x16x32_bf16 v[84:87], v[52:55], v[176:179], v[84:87]
ds_read_b64_tr_b16 v[44:45], v1 offset:20480
ds_read_b64_tr_b16 v[46:47], v1 offset:20992
v_mfma_f32_16x16x32_bf16 v[84:87], v[56:59], v[184:187], v[84:87]
ds_read_b64_tr_b16 v[48:49], v1 offset:24576
ds_read_b64_tr_b16 v[50:51], v1 offset:25088
v_mfma_f32_16x16x32_bf16 v[92:95], v[56:59], v[188:191], v[92:95]
ds_read_b64_tr_b16 v[52:53], v2 offset:24576
ds_read_b64_tr_b16 v[54:55], v2 offset:25088
v_mfma_f32_16x16x32_bf16 v[88:91], v[60:63], v[188:191], v[88:91]
ds_read_b64_tr_b16 v[56:57], v2 offset:28672
ds_read_b64_tr_b16 v[58:59], v2 offset:29184
v_mfma_f32_16x16x32_bf16 v[80:83], v[60:63], v[184:187], v[80:83]
ds_read_b64_tr_b16 v[60:61], v1 offset:28672
ds_read_b64_tr_b16 v[62:63], v1 offset:29184
s_waitcnt lgkmcnt(8)
v_mfma_f32_16x16x32_bf16 v[80:83], v[32:35], v[192:195], v[80:83]
v_mfma_f32_16x16x32_bf16 v[88:91], v[32:35], v[196:199], v[88:91]
v_mfma_f32_16x16x32_bf16 v[92:95], v[36:39], v[196:199], v[92:95]
v_mfma_f32_16x16x32_bf16 v[84:87], v[36:39], v[192:195], v[84:87]
v_mfma_f32_16x16x32_bf16 v[84:87], v[40:43], v[200:203], v[84:87]
v_mfma_f32_16x16x32_bf16 v[92:95], v[40:43], v[204:207], v[92:95]
v_mfma_f32_16x16x32_bf16 v[88:91], v[44:47], v[204:207], v[88:91]
v_mfma_f32_16x16x32_bf16 v[80:83], v[44:47], v[200:203], v[80:83]
s_waitcnt lgkmcnt(0)
s_barrier
v_mfma_f32_16x16x32_bf16 v[80:83], v[48:51], v[208:211], v[80:83]
ds_read_b64_tr_b16 v[32:33], v3 offset:0
ds_read_b64_tr_b16 v[34:35], v3 offset:512
v_mfma_f32_16x16x32_bf16 v[88:91], v[48:51], v[212:215], v[88:91]
ds_read_b64_tr_b16 v[36:37], v13 offset:0
ds_read_b64_tr_b16 v[38:39], v13 offset:512
v_mfma_f32_16x16x32_bf16 v[92:95], v[52:55], v[212:215], v[92:95]
ds_read_b64_tr_b16 v[40:41], v13 offset:4096
ds_read_b64_tr_b16 v[42:43], v13 offset:4608
v_mfma_f32_16x16x32_bf16 v[84:87], v[52:55], v[208:211], v[84:87]
ds_read_b64_tr_b16 v[44:45], v3 offset:4096
ds_read_b64_tr_b16 v[46:47], v3 offset:4608
v_mfma_f32_16x16x32_bf16 v[84:87], v[56:59], v[216:219], v[84:87]
ds_read_b64_tr_b16 v[48:49], v3 offset:8192
ds_read_b64_tr_b16 v[50:51], v3 offset:8704
v_mfma_f32_16x16x32_bf16 v[92:95], v[56:59], v[220:223], v[92:95]
ds_read_b64_tr_b16 v[52:53], v13 offset:8192
ds_read_b64_tr_b16 v[54:55], v13 offset:8704
v_mfma_f32_16x16x32_bf16 v[88:91], v[60:63], v[220:223], v[88:91]
ds_read_b64_tr_b16 v[56:57], v13 offset:12288
ds_read_b64_tr_b16 v[58:59], v13 offset:12800
v_mfma_f32_16x16x32_bf16 v[80:83], v[60:63], v[216:219], v[80:83]
s_waitcnt vmcnt(0)
s_atomic_swap s51, s[70:71], 0
ds_read_b64_tr_b16 v[60:61], v3 offset:12288
ds_read_b64_tr_b16 v[62:63], v3 offset:12800
s_waitcnt lgkmcnt(8)
v_mfma_f32_16x16x32_bf16 v[80:83], v[32:35], v[224:227], v[80:83]
v_mfma_f32_16x16x32_bf16 v[88:91], v[32:35], v[228:231], v[88:91]
v_mfma_f32_16x16x32_bf16 v[92:95], v[36:39], v[228:231], v[92:95]
v_mfma_f32_16x16x32_bf16 v[84:87], v[36:39], v[224:227], v[84:87]
v_mfma_f32_16x16x32_bf16 v[84:87], v[40:43], v[232:235], v[84:87]
v_mfma_f32_16x16x32_bf16 v[92:95], v[40:43], v[236:239], v[92:95]
v_mfma_f32_16x16x32_bf16 v[88:91], v[44:47], v[236:239], v[88:91]
v_mfma_f32_16x16x32_bf16 v[80:83], v[44:47], v[232:235], v[80:83]
ds_read_b32 v7, v1
s_waitcnt lgkmcnt(1)
s_barrier
v_mfma_f32_16x16x32_bf16 v[80:83], v[48:51], v[240:243], v[80:83]
ds_read_b64_tr_b16 v[32:33], v3 offset:16384
ds_read_b64_tr_b16 v[34:35], v3 offset:16896
v_mfma_f32_16x16x32_bf16 v[88:91], v[48:51], v[244:247], v[88:91]
ds_read_b64_tr_b16 v[36:37], v13 offset:16384
ds_read_b64_tr_b16 v[38:39], v13 offset:16896
v_mfma_f32_16x16x32_bf16 v[92:95], v[52:55], v[244:247], v[92:95]
ds_read_b64_tr_b16 v[40:41], v13 offset:20480
ds_read_b64_tr_b16 v[42:43], v13 offset:20992
v_mfma_f32_16x16x32_bf16 v[84:87], v[52:55], v[240:243], v[84:87]
ds_read_b64_tr_b16 v[44:45], v3 offset:20480
ds_read_b64_tr_b16 v[46:47], v3 offset:20992
v_mfma_f32_16x16x32_bf16 v[84:87], v[56:59], v[248:251], v[84:87]
ds_read_b64_tr_b16 v[48:49], v3 offset:24576
ds_read_b64_tr_b16 v[50:51], v3 offset:25088
v_mfma_f32_16x16x32_bf16 v[92:95], v[56:59], v[252:255], v[92:95]
ds_read_b64_tr_b16 v[52:53], v13 offset:24576
ds_read_b64_tr_b16 v[54:55], v13 offset:25088
v_mfma_f32_16x16x32_bf16 v[88:91], v[60:63], v[252:255], v[88:91]
ds_read_b64_tr_b16 v[56:57], v13 offset:28672
ds_read_b64_tr_b16 v[58:59], v13 offset:29184
v_mfma_f32_16x16x32_bf16 v[80:83], v[60:63], v[248:251], v[80:83]
ds_read_b64_tr_b16 v[60:61], v3 offset:28672
ds_read_b64_tr_b16 v[62:63], v3 offset:29184
s_waitcnt lgkmcnt(8)
v_mfma_f32_16x16x32_bf16 v[64:67], v[32:35], v[96:99], 0
v_mfma_f32_16x16x32_bf16 v[72:75], v[32:35], v[100:103], 0
v_mfma_f32_16x16x32_bf16 v[64:67], v[8:11], v[10:13], v[64:67]
v_mfma_f32_16x16x32_bf16 v[72:75], v[8:11], v[10:13], v[72:75]
v_xor_b32 v10, 0x3f80, v10
v_mfma_f32_16x16x32_bf16 v[76:79], v[36:39], v[100:103], 0
v_mfma_f32_16x16x32_bf16 v[68:71], v[36:39], v[96:99], 0
v_mfma_f32_16x16x32_bf16 v[68:71], v[8:11], v[10:13], v[68:71]
v_mfma_f32_16x16x32_bf16 v[76:79], v[8:11], v[10:13], v[76:79]
v_xor_b32 v10, 0x3f80, v10
s_add_u32 s61, s61, 8192
v_pk_mul_f32 v[24:25], v[80:81], v[80:81]
v_pk_mul_f32 v[26:27], v[82:83], v[82:83]
v_pk_mul_f32 v[28:29], v[84:85], v[84:85]
v_pk_mul_f32 v[30:31], v[86:87], v[86:87]
v_pk_fma_f32 v[24:25], v[24:25], v[4:5], s[76:77] op_sel:[0,1,0] op_sel_hi:[1,1,1]
v_pk_fma_f32 v[26:27], v[26:27], v[4:5], s[76:77] op_sel:[0,1,0] op_sel_hi:[1,1,1]
v_pk_fma_f32 v[28:29], v[28:29], v[4:5], s[76:77] op_sel:[0,1,0] op_sel_hi:[1,1,1]
v_pk_fma_f32 v[30:31], v[30:31], v[4:5], s[76:77] op_sel:[0,1,0] op_sel_hi:[1,1,1]
v_pk_mul_f32 v[24:25], v[80:81], v[24:25]
v_pk_mul_f32 v[26:27], v[82:83], v[26:27]
v_pk_mul_f32 v[28:29], v[84:85], v[28:29]
v_pk_mul_f32 v[30:31], v[86:87], v[30:31]
v_exp_f32 v24, v24
v_exp_f32 v25, v25
v_exp_f32 v26, v26
v_exp_f32 v27, v27
v_exp_f32 v28, v28
v_exp_f32 v29, v29
v_exp_f32 v30, v30
v_exp_f32 v31, v31
v_pk_add_f32 v[24:25], v[24:25], 1.0 op_sel_hi:[1,0]
v_pk_add_f32 v[26:27], v[26:27], 1.0 op_sel_hi:[1,0]
v_pk_add_f32 v[28:29], v[28:29], 1.0 op_sel_hi:[1,0]
v_pk_add_f32 v[30:31], v[30:31], 1.0 op_sel_hi:[1,0]
v_rcp_f32 v24, v24
v_rcp_f32 v25, v25
v_rcp_f32 v26, v26
v_rcp_f32 v27, v27
v_rcp_f32 v28, v28
v_rcp_f32 v29, v29
v_rcp_f32 v30, v30
v_rcp_f32 v31, v31
v_pk_mul_f32 v[24:25], v[80:81], v[24:25]
v_pk_mul_f32 v[26:27], v[82:83], v[26:27]
v_pk_mul_f32 v[28:29], v[84:85], v[28:29]
v_pk_mul_f32 v[30:31], v[86:87], v[30:31]
v_cvt_pk_bf16_f32 v80, v24, v25
v_cvt_pk_bf16_f32 v81, v26, v27
v_cvt_pk_bf16_f32 v82, v28, v29
v_cvt_pk_bf16_f32 v83, v30, v31
buffer_store_dwordx4 v[80:83], v14, s[32:35], s61 offen sc1
v_pk_mul_f32 v[24:25], v[88:89], v[88:89]
v_pk_mul_f32 v[26:27], v[90:91], v[90:91]
v_pk_mul_f32 v[28:29], v[92:93], v[92:93]
v_pk_mul_f32 v[30:31], v[94:95], v[94:95]
v_pk_fma_f32 v[24:25], v[24:25], v[4:5], s[76:77] op_sel:[0,1,0] op_sel_hi:[1,1,1]
v_pk_fma_f32 v[26:27], v[26:27], v[4:5], s[76:77] op_sel:[0,1,0] op_sel_hi:[1,1,1]
v_pk_fma_f32 v[28:29], v[28:29], v[4:5], s[76:77] op_sel:[0,1,0] op_sel_hi:[1,1,1]
v_pk_fma_f32 v[30:31], v[30:31], v[4:5], s[76:77] op_sel:[0,1,0] op_sel_hi:[1,1,1]
v_pk_mul_f32 v[24:25], v[88:89], v[24:25]
v_pk_mul_f32 v[26:27], v[90:91], v[26:27]
v_pk_mul_f32 v[28:29], v[92:93], v[28:29]
v_pk_mul_f32 v[30:31], v[94:95], v[30:31]
v_exp_f32 v24, v24
v_exp_f32 v25, v25
v_exp_f32 v26, v26
v_exp_f32 v27, v27
v_exp_f32 v28, v28
v_exp_f32 v29, v29
v_exp_f32 v30, v30
v_exp_f32 v31, v31
v_pk_add_f32 v[24:25], v[24:25], 1.0 op_sel_hi:[1,0]
v_pk_add_f32 v[26:27], v[26:27], 1.0 op_sel_hi:[1,0]
v_pk_add_f32 v[28:29], v[28:29], 1.0 op_sel_hi:[1,0]
v_pk_add_f32 v[30:31], v[30:31], 1.0 op_sel_hi:[1,0]
v_rcp_f32 v24, v24
v_rcp_f32 v25, v25
v_rcp_f32 v26, v26
v_rcp_f32 v27, v27
v_rcp_f32 v28, v28
v_rcp_f32 v29, v29
v_rcp_f32 v30, v30
v_rcp_f32 v31, v31
v_pk_mul_f32 v[24:25], v[88:89], v[24:25]
v_pk_mul_f32 v[26:27], v[90:91], v[26:27]
v_pk_mul_f32 v[28:29], v[92:93], v[28:29]
v_pk_mul_f32 v[30:31], v[94:95], v[30:31]
v_cvt_pk_bf16_f32 v84, v24, v25
v_cvt_pk_bf16_f32 v85, v26, v27
v_cvt_pk_bf16_f32 v86, v28, v29
v_cvt_pk_bf16_f32 v87, v30, v31
buffer_store_dwordx4 v[84:87], v15, s[32:35], s61 offen sc1
v_mfma_f32_16x16x32_bf16 v[68:71], v[40:43], v[104:107], v[68:71]
v_mfma_f32_16x16x32_bf16 v[76:79], v[40:43], v[108:111], v[76:79]
v_mfma_f32_16x16x32_bf16 v[72:75], v[44:47], v[108:111], v[72:75]
v_mfma_f32_16x16x32_bf16 v[64:67], v[44:47], v[104:107], v[64:67]
v_lshrrev_b32 v111, 2, v0
v_lshlrev_b32 v96, 7, v111
ds_read_b32 v7, v1
s_waitcnt lgkmcnt(1)
s_barrier
v_mfma_f32_16x16x32_bf16 v[64:67], v[48:51], v[112:115], v[64:67]
ds_read_b64_tr_b16 v[32:33], v3 offset:32768
ds_read_b64_tr_b16 v[34:35], v3 offset:33280
v_mfma_f32_16x16x32_bf16 v[72:75], v[48:51], v[116:119], v[72:75]
ds_read_b64_tr_b16 v[36:37], v13 offset:32768
ds_read_b64_tr_b16 v[38:39], v13 offset:33280
v_mfma_f32_16x16x32_bf16 v[76:79], v[52:55], v[116:119], v[76:79]
ds_read_b64_tr_b16 v[40:41], v13 offset:36864
ds_read_b64_tr_b16 v[42:43], v13 offset:37376
v_mfma_f32_16x16x32_bf16 v[68:71], v[52:55], v[112:115], v[68:71]
ds_read_b64_tr_b16 v[44:45], v3 offset:36864
ds_read_b64_tr_b16 v[46:47], v3 offset:37376
v_mfma_f32_16x16x32_bf16 v[68:71], v[56:59], v[120:123], v[68:71]
ds_read_b64_tr_b16 v[48:49], v1 offset:32768
ds_read_b64_tr_b16 v[50:51], v1 offset:33280
v_mfma_f32_16x16x32_bf16 v[76:79], v[56:59], v[124:127], v[76:79]
ds_read_b64_tr_b16 v[52:53], v2 offset:32768
ds_read_b64_tr_b16 v[54:55], v2 offset:33280
v_mfma_f32_16x16x32_bf16 v[72:75], v[60:63], v[124:127], v[72:75]
ds_read_b64_tr_b16 v[56:57], v2 offset:36864
ds_read_b64_tr_b16 v[58:59], v2 offset:37376
v_mfma_f32_16x16x32_bf16 v[64:67], v[60:63], v[120:123], v[64:67]
ds_read_b64_tr_b16 v[60:61], v1 offset:36864
ds_read_b64_tr_b16 v[62:63], v1 offset:37376
s_waitcnt lgkmcnt(8)
v_mfma_f32_16x16x32_bf16 v[64:67], v[32:35], v[128:131], v[64:67]
v_bfe_u32 v111, v0, 3, 2
v_lshl_add_u32 v96, v111, 5, v96
v_mfma_f32_16x16x32_bf16 v[72:75], v[32:35], v[132:135], v[72:75]
v_and_b32 v111, 3, v0
v_lshl_add_u32 v96, v111, 3, v96
v_mfma_f32_16x16x32_bf16 v[76:79], v[36:39], v[132:135], v[76:79]
s_lshl_b32 s58, s57, 12
v_add_u32 v96, s58, v96
v_mfma_f32_16x16x32_bf16 v[68:71], v[36:39], v[128:131], v[68:71]
s_load_dwordx8 s[80:87], s[88:89], 0 glc
v_xor_b32 v97, 32, v96
v_xor_b32 v98, 64, v96
v_mfma_f32_16x16x32_bf16 v[68:71], v[40:43], v[136:139], v[68:71]
v_xor_b32 v99, 96, v96
v_add_u32 v100, 0x10000, v96
v_mfma_f32_16x16x32_bf16 v[76:79], v[40:43], v[140:143], v[76:79]
v_add_u32 v101, 0x10000, v97
v_add_u32 v102, 0x10000, v98
v_mfma_f32_16x16x32_bf16 v[72:75], v[44:47], v[140:143], v[72:75]
v_add_u32 v103, 0x10000, v99
v_add_u32 v104, 0x20000, v96
v_mfma_f32_16x16x32_bf16 v[64:67], v[44:47], v[136:139], v[64:67]
v_add_u32 v105, 0x20000, v97
v_add_u32 v106, 0x20000, v98
ds_read_b32 v7, v1
ds_read_b32 v7, v1
ds_read_b32 v7, v1
s_waitcnt lgkmcnt(3)
s_barrier
v_mfma_f32_16x16x32_bf16 v[64:67], v[48:51], v[144:147], v[64:67]
ds_read_b64_tr_b16 v[32:33], v1 offset:40960
ds_read_b64_tr_b16 v[34:35], v1 offset:41472
v_mfma_f32_16x16x32_bf16 v[72:75], v[48:51], v[148:151], v[72:75]
ds_read_b64_tr_b16 v[36:37], v2 offset:40960
ds_read_b64_tr_b16 v[38:39], v2 offset:41472
v_mfma_f32_16x16x32_bf16 v[76:79], v[52:55], v[148:151], v[76:79]
ds_read_b64_tr_b16 v[40:41], v2 offset:45056
ds_read_b64_tr_b16 v[42:43], v2 offset:45568
v_mfma_f32_16x16x32_bf16 v[68:71], v[52:55], v[144:147], v[68:71]
ds_read_b64_tr_b16 v[44:45], v1 offset:45056
ds_read_b64_tr_b16 v[46:47], v1 offset:45568
v_mfma_f32_16x16x32_bf16 v[68:71], v[56:59], v[152:155], v[68:71]
ds_read_b64_tr_b16 v[48:49], v1 offset:49152
ds_read_b64_tr_b16 v[50:51], v1 offset:49664
v_mfma_f32_16x16x32_bf16 v[76:79], v[56:59], v[156:159], v[76:79]
ds_read_b64_tr_b16 v[52:53], v2 offset:49152
ds_read_b64_tr_b16 v[54:55], v2 offset:49664
v_mfma_f32_16x16x32_bf16 v[72:75], v[60:63], v[156:159], v[72:75]
ds_read_b64_tr_b16 v[56:57], v2 offset:53248
ds_read_b64_tr_b16 v[58:59], v2 offset:53760
v_mfma_f32_16x16x32_bf16 v[64:67], v[60:63], v[152:155], v[64:67]
ds_read_b64_tr_b16 v[60:61], v1 offset:53248
ds_read_b64_tr_b16 v[62:63], v1 offset:53760
s_waitcnt lgkmcnt(8)
v_mfma_f32_16x16x32_bf16 v[64:67], v[32:35], v[160:163], v[64:67]
v_add_u32 v107, 0x20000, v99
s_lshl_b32 s58, s57, 10
v_mfma_f32_16x16x32_bf16 v[72:75], v[32:35], v[164:167], v[72:75]
v_lshl_add_u32 v108, v0, 4, s58
v_add_u32 v109, 0x10000, v108
v_mfma_f32_16x16x32_bf16 v[76:79], v[36:39], v[164:167], v[76:79]
v_add_u32 v110, 0x20000, v108
v_mov_b32 v24, 0
v_mfma_f32_16x16x32_bf16 v[68:71], v[36:39], v[160:163], v[68:71]
v_mov_b32 v26, 0
v_mov_b32 v27, 0
v_mfma_f32_16x16x32_bf16 v[68:71], v[40:43], v[168:171], v[68:71]
v_mov_b32 v28, 0x3f80
v_mov_b32 v29, 0x3f800000
v_mfma_f32_16x16x32_bf16 v[76:79], v[40:43], v[172:175], v[76:79]
v_mfma_f32_16x16x32_bf16 v[72:75], v[44:47], v[172:175], v[72:75]
v_mfma_f32_16x16x32_bf16 v[64:67], v[44:47], v[168:171], v[64:67]
ds_read_b32 v7, v1
ds_read_b32 v7, v1
ds_read_b32 v7, v1
s_waitcnt lgkmcnt(3)
s_barrier
v_mfma_f32_16x16x32_bf16 v[64:67], v[48:51], v[176:179], v[64:67]
ds_read_b64_tr_b16 v[32:33], v1 offset:0
ds_read_b64_tr_b16 v[34:35], v1 offset:512
v_mfma_f32_16x16x32_bf16 v[72:75], v[48:51], v[180:183], v[72:75]
ds_read_b64_tr_b16 v[36:37], v2 offset:0
ds_read_b64_tr_b16 v[38:39], v2 offset:512
v_mfma_f32_16x16x32_bf16 v[76:79], v[52:55], v[180:183], v[76:79]
ds_read_b64_tr_b16 v[40:41], v2 offset:4096
ds_read_b64_tr_b16 v[42:43], v2 offset:4608
v_mfma_f32_16x16x32_bf16 v[68:71], v[52:55], v[176:179], v[68:71]
ds_read_b64_tr_b16 v[44:45], v1 offset:4096
ds_read_b64_tr_b16 v[46:47], v1 offset:4608
v_mfma_f32_16x16x32_bf16 v[68:71], v[56:59], v[184:187], v[68:71]
ds_read_b64_tr_b16 v[48:49], v1 offset:8192
ds_read_b64_tr_b16 v[50:51], v1 offset:8704
v_mfma_f32_16x16x32_bf16 v[76:79], v[56:59], v[188:191], v[76:79]
ds_read_b64_tr_b16 v[52:53], v2 offset:8192
ds_read_b64_tr_b16 v[54:55], v2 offset:8704
v_mfma_f32_16x16x32_bf16 v[72:75], v[60:63], v[188:191], v[72:75]
ds_read_b64_tr_b16 v[56:57], v2 offset:12288
ds_read_b64_tr_b16 v[58:59], v2 offset:12800
v_mfma_f32_16x16x32_bf16 v[64:67], v[60:63], v[184:187], v[64:67]
ds_read_b64_tr_b16 v[60:61], v1 offset:12288
ds_read_b64_tr_b16 v[62:63], v1 offset:12800
s_waitcnt lgkmcnt(8)
v_mfma_f32_16x16x32_bf16 v[64:67], v[32:35], v[192:195], v[64:67]
v_mfma_f32_16x16x32_bf16 v[72:75], v[32:35], v[196:199], v[72:75]
v_mfma_f32_16x16x32_bf16 v[76:79], v[36:39], v[196:199], v[76:79]
v_mfma_f32_16x16x32_bf16 v[68:71], v[36:39], v[192:195], v[68:71]
v_mfma_f32_16x16x32_bf16 v[68:71], v[40:43], v[200:203], v[68:71]
v_mfma_f32_16x16x32_bf16 v[76:79], v[40:43], v[204:207], v[76:79]
s_bfm_b64 s[64:65], 16, 0
v_cndmask_b32 v25, v11, v28, s[64:65]
v_mfma_f32_16x16x32_bf16 v[72:75], v[44:47], v[204:207], v[72:75]
v_mfma_f32_16x16x32_bf16 v[64:67], v[44:47], v[200:203], v[64:67]
v_mfma_f32_16x16x32_bf16 v[176:179], v[8:11], v[24:27], 0
s_bfm_b64 s[64:65], 16, 16
v_cndmask_b32 v25, v11, v28, s[64:65]
ds_read_b32 v7, v1
ds_read_b32 v7, v1
s_waitcnt lgkmcnt(2)
s_barrier
v_mfma_f32_16x16x32_bf16 v[64:67], v[48:51], v[208:211], v[64:67]
ds_read_b64_tr_b16 v[32:33], v1 offset:16384
ds_read_b64_tr_b16 v[34:35], v1 offset:16896
v_mfma_f32_16x16x32_bf16 v[72:75], v[48:51], v[212:215], v[72:75]
v_mfma_f32_16x16x32_bf16 v[180:183], v[8:11], v[24:27], 0
s_bfm_b64 s[64:65], 16, 32
v_cndmask_b32 v25, v11, v28, s[64:65]
ds_read_b64_tr_b16 v[36:37], v2 offset:16384
ds_read_b64_tr_b16 v[38:39], v2 offset:16896
v_mfma_f32_16x16x32_bf16 v[76:79], v[52:55], v[212:215], v[76:79]
ds_read_b64_tr_b16 v[40:41], v2 offset:20480
ds_read_b64_tr_b16 v[42:43], v2 offset:20992
v_mfma_f32_16x16x32_bf16 v[68:71], v[52:55], v[208:211], v[68:71]
v_mfma_f32_16x16x32_bf16 v[184:187], v[8:11], v[24:27], 0
s_bfm_b64 s[64:65], 16, 48
v_cndmask_b32 v25, v11, v28, s[64:65]
ds_read_b64_tr_b16 v[44:45], v1 offset:20480
ds_read_b64_tr_b16 v[46:47], v1 offset:20992
v_mfma_f32_16x16x32_bf16 v[68:71], v[56:59], v[216:219], v[68:71]
ds_read_b64_tr_b16 v[48:49], v1 offset:24576
ds_read_b64_tr_b16 v[50:51], v1 offset:25088
v_mfma_f32_16x16x32_bf16 v[76:79], v[56:59], v[220:223], v[76:79]
v_mfma_f32_16x16x32_bf16 v[188:191], v[8:11], v[24:27], 0
s_bfm_b64 s[64:65], 16, 0
v_cndmask_b32 v25, v11, v29, s[64:65]
ds_read_b64_tr_b16 v[52:53], v2 offset:24576
ds_read_b64_tr_b16 v[54:55], v2 offset:25088
v_mfma_f32_16x16x32_bf16 v[72:75], v[60:63], v[220:223], v[72:75]
ds_read_b64_tr_b16 v[56:57], v2 offset:28672
ds_read_b64_tr_b16 v[58:59], v2 offset:29184
v_mfma_f32_16x16x32_bf16 v[64:67], v[60:63], v[216:219], v[64:67]
v_mfma_f32_16x16x32_bf16 v[192:195], v[8:11], v[24:27], 0
ds_read_b64_tr_b16 v[60:61], v1 offset:28672
ds_read_b64_tr_b16 v[62:63], v1 offset:29184
s_waitcnt lgkmcnt(8)
v_mfma_f32_16x16x32_bf16 v[64:67], v[32:35], v[224:227], v[64:67]
v_mfma_f32_16x16x32_bf16 v[72:75], v[32:35], v[228:231], v[72:75]
v_mfma_f32_16x16x32_bf16 v[76:79], v[36:39], v[228:231], v[76:79]
v_mfma_f32_16x16x32_bf16 v[68:71], v[36:39], v[224:227], v[68:71]
v_mfma_f32_16x16x32_bf16 v[68:71], v[40:43], v[232:235], v[68:71]
v_mfma_f32_16x16x32_bf16 v[76:79], v[40:43], v[236:239], v[76:79]
s_waitcnt lgkmcnt(0)
s_xor_b64 s[80:81], s[80:81], s[78:79]
s_xor_b64 s[82:83], s[82:83], s[78:79]
s_xor_b64 s[84:85], s[84:85], s[78:79]
s_xor_b64 s[86:87], s[86:87], s[78:79]
s_or_b64 s[80:81], s[80:81], s[82:83]
s_or_b64 s[84:85], s[84:85], s[86:87]
s_or_b64 s[80:81], s[80:81], s[84:85]
s_cbranch_scc1 L_poll0
L_pollok0:
buffer_load_dwordx4 v[112:115], v15, s[32:35], s7 offen sc1
v_mfma_f32_16x16x32_bf16 v[72:75], v[44:47], v[236:239], v[72:75]
v_mfma_f32_16x16x32_bf16 v[64:67], v[44:47], v[232:235], v[64:67]
s_waitcnt vmcnt(1)
s_atomic_swap s51, s[70:71], 256
buffer_load_dwordx4 v[116:119], v14, s[32:35], s7 offen sc1
v_mfma_f32_16x16x32_bf16 v[64:67], v[48:51], v[240:243], v[64:67]
v_mfma_f32_16x16x32_bf16 v[72:75], v[48:51], v[244:247], v[72:75]
buffer_load_dwordx4 v[120:123], v15, s[32:35], s8 offen sc1
v_mfma_f32_16x16x32_bf16 v[76:79], v[52:55], v[244:247], v[76:79]
v_mfma_f32_16x16x32_bf16 v[68:71], v[52:55], v[240:243], v[68:71]
buffer_load_dwordx4 v[124:127], v14, s[32:35], s8 offen sc1
v_mfma_f32_16x16x32_bf16 v[68:71], v[56:59], v[248:251], v[68:71]
v_mfma_f32_16x16x32_bf16 v[76:79], v[56:59], v[252:255], v[76:79]
buffer_load_dwordx4 v[128:131], v15, s[32:35], s9 offen sc1
v_mfma_f32_16x16x32_bf16 v[72:75], v[60:63], v[252:255], v[72:75]
v_mfma_f32_16x16x32_bf16 v[64:67], v[60:63], v[248:251], v[64:67]
buffer_load_dwordx4 v[132:135], v14, s[32:35], s9 offen sc1
s_branch L_pg3
.p2align 12
L_stub3:
s_setpc_b64 s[66:67]
s_nop 0
L_pg3:
s_barrier
ds_read_b64_tr_b16 v[196:197], v104 offset:22528
ds_read_b64_tr_b16 v[198:199], v104 offset:24576
ds_read_b64_tr_b16 v[200:201], v105 offset:22528
ds_read_b64_tr_b16 v[202:203], v105 offset:24576
ds_read_b64_tr_b16 v[204:205], v106 offset:22528
ds_read_b64_tr_b16 v[206:207], v106 offset:24576
ds_read_b64_tr_b16 v[208:209], v107 offset:22528
ds_read_b64_tr_b16 v[210:211], v107 offset:24576
ds_read_b128 v[212:215], v110 offset:30720
ds_read_b64_tr_b16 v[216:217], v104 offset:12288
ds_read_b64_tr_b16 v[218:219], v104 offset:14336
ds_read_b64_tr_b16 v[220:221], v105 offset:12288
ds_read_b64_tr_b16 v[222:223], v105 offset:14336
ds_read_b64_tr_b16 v[224:225], v106 offset:12288
ds_read_b64_tr_b16 v[226:227], v106 offset:14336
ds_read_b64_tr_b16 v[228:229], v107 offset:12288
ds_read_b64_tr_b16 v[230:231], v107 offset:14336
ds_read_b128 v[232:235], v110 offset:20480
buffer_load_dwordx4 v[136:139], v15, s[32:35], s10 offen sc1
buffer_load_dwordx4 v[140:143], v14, s[32:35], s10 offen sc1
s_nop 1
s_add_u32 s61, s61, 8192
v_pk_mul_f32 v[24:25], v[64:65], v[64:65]
v_pk_mul_f32 v[26:27], v[66:67], v[66:67]
v_pk_mul_f32 v[28:29], v[68:69], v[68:69]
v_pk_mul_f32 v[30:31], v[70:71], v[70:71]
v_pk_fma_f32 v[24:25], v[24:25], v[4:5], s[76:77] op_sel:[0,1,0] op_sel_hi:[1,1,1]
v_pk_fma_f32 v[26:27], v[26:27], v[4:5], s[76:77] op_sel:[0,1,0] op_sel_hi:[1,1,1]
v_pk_fma_f32 v[28:29], v[28:29], v[4:5], s[76:77] op_sel:[0,1,0] op_sel_hi:[1,1,1]
v_pk_fma_f32 v[30:31], v[30:31], v[4:5], s[76:77] op_sel:[0,1,0] op_sel_hi:[1,1,1]
v_pk_mul_f32 v[24:25], v[64:65], v[24:25]
v_pk_mul_f32 v[26:27], v[66:67], v[26:27]
v_pk_mul_f32 v[28:29], v[68:69], v[28:29]
v_pk_mul_f32 v[30:31], v[70:71], v[30:31]
v_exp_f32 v24, v24
v_exp_f32 v25, v25
v_exp_f32 v26, v26
v_exp_f32 v27, v27
v_exp_f32 v28, v28
v_exp_f32 v29, v29
v_exp_f32 v30, v30
v_exp_f32 v31, v31
v_pk_add_f32 v[24:25], v[24:25], 1.0 op_sel_hi:[1,0]
v_pk_add_f32 v[26:27], v[26:27], 1.0 op_sel_hi:[1,0]
v_pk_add_f32 v[28:29], v[28:29], 1.0 op_sel_hi:[1,0]
v_pk_add_f32 v[30:31], v[30:31], 1.0 op_sel_hi:[1,0]
v_rcp_f32 v24, v24
v_rcp_f32 v25, v25
v_rcp_f32 v26, v26
v_rcp_f32 v27, v27
v_rcp_f32 v28, v28
v_rcp_f32 v29, v29
v_rcp_f32 v30, v30
v_rcp_f32 v31, v31
v_pk_mul_f32 v[24:25], v[64:65], v[24:25]
v_pk_mul_f32 v[26:27], v[66:67], v[26:27]
v_pk_mul_f32 v[28:29], v[68:69], v[28:29]
v_pk_mul_f32 v[30:31], v[70:71], v[30:31]
v_cvt_pk_bf16_f32 v64, v24, v25
v_cvt_pk_bf16_f32 v65, v26, v27
v_cvt_pk_bf16_f32 v66, v28, v29
v_cvt_pk_bf16_f32 v67, v30, v31
buffer_store_dwordx4 v[64:67], v14, s[32:35], s61 offen sc1
v_pk_mul_f32 v[24:25], v[72:73], v[72:73]
v_pk_mul_f32 v[26:27], v[74:75], v[74:75]
v_pk_mul_f32 v[28:29], v[76:77], v[76:77]
v_pk_mul_f32 v[30:31], v[78:79], v[78:79]
v_pk_fma_f32 v[24:25], v[24:25], v[4:5], s[76:77] op_sel:[0,1,0] op_sel_hi:[1,1,1]
v_pk_fma_f32 v[26:27], v[26:27], v[4:5], s[76:77] op_sel:[0,1,0] op_sel_hi:[1,1,1]
v_pk_fma_f32 v[28:29], v[28:29], v[4:5], s[76:77] op_sel:[0,1,0] op_sel_hi:[1,1,1]
v_pk_fma_f32 v[30:31], v[30:31], v[4:5], s[76:77] op_sel:[0,1,0] op_sel_hi:[1,1,1]
v_pk_mul_f32 v[24:25], v[72:73], v[24:25]
v_pk_mul_f32 v[26:27], v[74:75], v[26:27]
v_pk_mul_f32 v[28:29], v[76:77], v[28:29]
v_pk_mul_f32 v[30:31], v[78:79], v[30:31]
v_exp_f32 v24, v24
v_exp_f32 v25, v25
v_exp_f32 v26, v26
v_exp_f32 v27, v27
v_exp_f32 v28, v28
v_exp_f32 v29, v29
v_exp_f32 v30, v30
v_exp_f32 v31, v31
v_pk_add_f32 v[24:25], v[24:25], 1.0 op_sel_hi:[1,0]
v_pk_add_f32 v[26:27], v[26:27], 1.0 op_sel_hi:[1,0]
v_pk_add_f32 v[28:29], v[28:29], 1.0 op_sel_hi:[1,0]
v_pk_add_f32 v[30:31], v[30:31], 1.0 op_sel_hi:[1,0]
v_rcp_f32 v24, v24
v_rcp_f32 v25, v25
v_rcp_f32 v26, v26
v_rcp_f32 v27, v27
v_rcp_f32 v28, v28
v_rcp_f32 v29, v29
v_rcp_f32 v30, v30
v_rcp_f32 v31, v31
v_pk_mul_f32 v[24:25], v[72:73], v[24:25]
v_pk_mul_f32 v[26:27], v[74:75], v[26:27]
v_pk_mul_f32 v[28:29], v[76:77], v[28:29]
v_pk_mul_f32 v[30:31], v[78:79], v[30:31]
v_cvt_pk_bf16_f32 v68, v24, v25
v_cvt_pk_bf16_f32 v69, v26, v27
v_cvt_pk_bf16_f32 v70, v28, v29
v_cvt_pk_bf16_f32 v71, v30, v31
buffer_store_dwordx4 v[68:71], v15, s[32:35], s61 offen sc1
s_waitcnt lgkmcnt(9)
v_mfma_f32_16x16x32_bf16 v[32:35], v[196:199], v[20:23], 0
ds_read_b64_tr_b16 v[236:237], v104 offset:2048
ds_read_b64_tr_b16 v[238:239], v104 offset:4096
s_load_dwordx8 s[80:87], s[88:89], 256 glc
v_mfma_f32_16x16x32_bf16 v[176:179], v[196:199], v[16:19], v[176:179]
ds_read_b64_tr_b16 v[240:241], v105 offset:2048
v_mfma_f32_16x16x32_bf16 v[36:39], v[200:203], v[20:23], 0
v_mfma_f32_16x16x32_bf16 v[180:183], v[200:203], v[16:19], v[180:183]
ds_read_b64_tr_b16 v[242:243], v105 offset:4096
ds_read_b64_tr_b16 v[244:245], v106 offset:2048
v_mfma_f32_16x16x32_bf16 v[40:43], v[204:207], v[20:23], 0
ds_read_b64_tr_b16 v[246:247], v106 offset:4096
v_mfma_f32_16x16x32_bf16 v[184:187], v[204:207], v[16:19], v[184:187]
v_mfma_f32_16x16x32_bf16 v[44:47], v[208:211], v[20:23], 0
ds_read_b64_tr_b16 v[248:249], v107 offset:2048
ds_read_b64_tr_b16 v[250:251], v107 offset:4096
v_mfma_f32_16x16x32_bf16 v[188:191], v[208:211], v[16:19], v[188:191]
ds_read_b128 v[252:255], v110 offset:10240
v_mfma_f32_16x16x32_bf16 v[48:51], v[212:215], v[20:23], 0
v_mfma_f32_16x16x32_bf16 v[192:195], v[212:215], v[16:19], v[192:195]
s_barrier
s_waitcnt lgkmcnt(9)
v_mfma_f32_16x16x32_bf16 v[32:35], v[216:219], v[84:87], v[32:35]
ds_read_b64_tr_b16 v[196:197], v100 offset:57344
ds_read_b64_tr_b16 v[198:199], v100 offset:59392
v_mfma_f32_16x16x32_bf16 v[176:179], v[216:219], v[80:83], v[176:179]
ds_read_b64_tr_b16 v[200:201], v101 offset:57344
v_mfma_f32_16x16x32_bf16 v[36:39], v[220:223], v[84:87], v[36:39]
v_mfma_f32_16x16x32_bf16 v[180:183], v[220:223], v[80:83], v[180:183]
ds_read_b64_tr_b16 v[202:203], v101 offset:59392
ds_read_b64_tr_b16 v[204:205], v102 offset:57344
v_mfma_f32_16x16x32_bf16 v[40:43], v[224:227], v[84:87], v[40:43]
ds_read_b64_tr_b16 v[206:207], v102 offset:59392
v_mfma_f32_16x16x32_bf16 v[184:187], v[224:227], v[80:83], v[184:187]
v_mfma_f32_16x16x32_bf16 v[44:47], v[228:231], v[84:87], v[44:47]
ds_read_b64_tr_b16 v[208:209], v103 offset:57344
ds_read_b64_tr_b16 v[210:211], v103 offset:59392
v_mfma_f32_16x16x32_bf16 v[188:191], v[228:231], v[80:83], v[188:191]
ds_read_b128 v[212:215], v110 offset:0
v_mfma_f32_16x16x32_bf16 v[48:51], v[232:235], v[84:87], v[48:51]
v_mfma_f32_16x16x32_bf16 v[192:195], v[232:235], v[80:83], v[192:195]
s_waitcnt lgkmcnt(9)
v_mfma_f32_16x16x32_bf16 v[32:35], v[236:239], v[68:71], v[32:35]
ds_read_b64_tr_b16 v[216:217], v100 offset:47104
ds_read_b64_tr_b16 v[218:219], v100 offset:49152
v_mfma_f32_16x16x32_bf16 v[176:179], v[236:239], v[64:67], v[176:179]
ds_read_b64_tr_b16 v[220:221], v101 offset:47104
v_mfma_f32_16x16x32_bf16 v[36:39], v[240:243], v[68:71], v[36:39]
v_mfma_f32_16x16x32_bf16 v[180:183], v[240:243], v[64:67], v[180:183]
ds_read_b64_tr_b16 v[222:223], v101 offset:49152
ds_read_b64_tr_b16 v[224:225], v102 offset:47104
v_mfma_f32_16x16x32_bf16 v[40:43], v[244:247], v[68:71], v[40:43]
ds_read_b64_tr_b16 v[226:227], v102 offset:49152
v_mfma_f32_16x16x32_bf16 v[184:187], v[244:247], v[64:67], v[184:187]
v_mfma_f32_16x16x32_bf16 v[44:47], v[248:251], v[68:71], v[44:47]
ds_read_b64_tr_b16 v[228:229], v103 offset:47104
ds_read_b64_tr_b16 v[230:231], v103 offset:49152
v_mfma_f32_16x16x32_bf16 v[188:191], v[248:251], v[64:67], v[188:191]
ds_read_b128 v[232:235], v109 offset:55296
v_mfma_f32_16x16x32_bf16 v[48:51], v[252:255], v[68:71], v[48:51]
v_mfma_f32_16x16x32_bf16 v[192:195], v[252:255], v[64:67], v[192:195]
s_waitcnt lgkmcnt(0)
s_xor_b64 s[80:81], s[80:81], s[78:79]
s_xor_b64 s[82:83], s[82:83], s[78:79]
s_xor_b64 s[84:85], s[84:85], s[78:79]
s_xor_b64 s[86:87], s[86:87], s[78:79]
s_or_b64 s[80:81], s[80:81], s[82:83]
s_or_b64 s[84:85], s[84:85], s[86:87]
s_or_b64 s[80:81], s[80:81], s[84:85]
s_cbranch_scc1 L_poll1
L_pollok1:
s_barrier
s_waitcnt lgkmcnt(9) vmcnt(8)
v_mfma_f32_16x16x32_bf16 v[32:35], v[196:199], v[112:115], v[32:35]
ds_read_b64_tr_b16 v[236:237], v100 offset:6144
ds_read_b64_tr_b16 v[238:239], v100 offset:8192
v_lshrrev_b32 v54, 4, v0
v_mfma_f32_16x16x32_bf16 v[176:179], v[196:199], v[116:119], v[176:179]
ds_read_b64_tr_b16 v[240:241], v101 offset:6144
s_lshl_b32 s58, s48, 2
v_mfma_f32_16x16x32_bf16 v[36:39], v[200:203], v[112:115], v[36:39]
buffer_load_dwordx4 v[144:147], v15, s[32:35], s11 offen sc1
s_lshl_b32 s59, s56, 1
v_mfma_f32_16x16x32_bf16 v[180:183], v[200:203], v[116:119], v[180:183]
ds_read_b64_tr_b16 v[242:243], v101 offset:8192
ds_read_b64_tr_b16 v[244:245], v102 offset:6144
s_add_u32 s58, s58, s59
v_mfma_f32_16x16x32_bf16 v[40:43], v[204:207], v[112:115], v[40:43]
ds_read_b64_tr_b16 v[246:247], v102 offset:8192
s_add_u32 s58, s58, s57
v_mfma_f32_16x16x32_bf16 v[184:187], v[204:207], v[116:119], v[184:187]
buffer_load_dwordx4 v[148:151], v14, s[32:35], s11 offen sc1
s_lshl_b32 s58, s58, 4
v_mfma_f32_16x16x32_bf16 v[44:47], v[208:211], v[112:115], v[44:47]
ds_read_b64_tr_b16 v[248:249], v103 offset:6144
ds_read_b64_tr_b16 v[250:251], v103 offset:8192
s_lshl_b32 s59, s50, 10
v_mfma_f32_16x16x32_bf16 v[188:191], v[208:211], v[116:119], v[188:191]
ds_read_b128 v[252:255], v109 offset:14336
s_add_u32 s60, s59, 143360
v_mfma_f32_16x16x32_bf16 v[48:51], v[212:215], v[112:115], v[48:51]
buffer_load_dwordx4 v[152:155], v15, s[32:35], s12 offen sc1
v_lshl_add_u32 v61, v0, 4, s60
v_mfma_f32_16x16x32_bf16 v[192:195], v[212:215], v[116:119], v[192:195]
s_xor_b32 s59, s59, 0x800
s_waitcnt lgkmcnt(9) vmcnt(9)
v_mfma_f32_16x16x32_bf16 v[32:35], v[216:219], v[120:123], v[32:35]
ds_read_b64_tr_b16 v[196:197], v100 offset:16384
ds_read_b64_tr_b16 v[198:199], v100 offset:18432
s_add_u32 s60, s59, 143360
v_mfma_f32_16x16x32_bf16 v[176:179], v[216:219], v[124:127], v[176:179]
ds_read_b64_tr_b16 v[200:201], v101 offset:16384
v_lshl_add_u32 v62, v0, 4, s60
v_mfma_f32_16x16x32_bf16 v[36:39], v[220:223], v[120:123], v[36:39]
buffer_load_dwordx4 v[156:159], v14, s[32:35], s12 offen sc1
s_mul_i32 s59, s50, 2816
v_mfma_f32_16x16x32_bf16 v[180:183], v[220:223], v[124:127], v[180:183]
ds_read_b64_tr_b16 v[202:203], v101 offset:18432
ds_read_b64_tr_b16 v[204:205], v102 offset:16384
s_add_u32 s59, s59, 122880
v_mfma_f32_16x16x32_bf16 v[40:43], v[224:227], v[120:123], v[40:43]
ds_read_b64_tr_b16 v[206:207], v102 offset:18432
v_and_b32 v55, 15, v0
v_mfma_f32_16x16x32_bf16 v[184:187], v[224:227], v[124:127], v[184:187]
buffer_load_dwordx4 v[112:115], v15, s[32:35], s13 offen sc1
v_mul_u32_u24 v55, 176, v55
s_waitcnt vmcnt(5)
s_atomic_swap s51, s[70:71], 512
v_mfma_f32_16x16x32_bf16 v[44:47], v[228:231], v[120:123], v[44:47]
ds_read_b64_tr_b16 v[208:209], v103 offset:16384
ds_read_b64_tr_b16 v[210:211], v103 offset:18432
v_add_u32 v55, s59, v55
v_mfma_f32_16x16x32_bf16 v[188:191], v[228:231], v[124:127], v[188:191]
ds_read_b128 v[212:215], v109 offset:24576
v_lshl_add_u32 v55, v54, 3, v55
v_mfma_f32_16x16x32_bf16 v[48:51], v[232:235], v[120:123], v[48:51]
buffer_load_dwordx4 v[116:119], v14, s[32:35], s13 offen sc1
v_lshrrev_b32 v58, 3, v0
v_mfma_f32_16x16x32_bf16 v[192:195], v[232:235], v[124:127], v[192:195]
v_and_b32 v59, 7, v0
s_barrier
s_waitcnt lgkmcnt(9)
v_mfma_f32_16x16x32_bf16 v[32:35], v[236:239], v[128:131], v[32:35]
ds_read_b64_tr_b16 v[216:217], v100 offset:36864
ds_read_b64_tr_b16 v[218:219], v100 offset:38912
v_mul_u32_u24 v56, 176, v58
v_mfma_f32_16x16x32_bf16 v[176:179], v[236:239], v[132:135], v[176:179]
ds_read_b64_tr_b16 v[220:221], v101 offset:36864
v_lshl_add_u32 v56, v59, 4, v56
v_mfma_f32_16x16x32_bf16 v[36:39], v[240:243], v[128:131], v[36:39]
buffer_load_dwordx4 v[120:123], v15, s[32:35], s14 offen sc1
v_add_u32 v56, s59, v56
v_mfma_f32_16x16x32_bf16 v[180:183], v[240:243], v[132:135], v[180:183]
ds_read_b64_tr_b16 v[222:223], v101 offset:38912
ds_read_b64_tr_b16 v[224:225], v102 offset:36864
v_add_u32 v58, s58, v58
v_mfma_f32_16x16x32_bf16 v[40:43], v[244:247], v[128:131], v[40:43]
ds_read_b64_tr_b16 v[226:227], v102 offset:38912
v_mul_u32_u24 v58, 1280, v58
v_mfma_f32_16x16x32_bf16 v[184:187], v[244:247], v[132:135], v[184:187]
buffer_load_dwordx4 v[124:127], v14, s[32:35], s14 offen sc1
v_lshl_add_u32 v58, v59, 4, v58
v_mfma_f32_16x16x32_bf16 v[44:47], v[248:251], v[128:131], v[44:47]
ds_read_b64_tr_b16 v[228:229], v103 offset:36864
ds_read_b64_tr_b16 v[230:231], v103 offset:38912
s_lshl_b32 s60, s49, 7
v_mfma_f32_16x16x32_bf16 v[188:191], v[248:251], v[132:135], v[188:191]
ds_read_b128 v[232:235], v109 offset:45056
v_add_u32 v58, s60, v58
v_mfma_f32_16x16x32_bf16 v[48:51], v[252:255], v[128:131], v[48:51]
v_bfe_u32 v59, v0, 1, 4
v_mfma_f32_16x16x32_bf16 v[192:195], v[252:255], v[132:135], v[192:195]
v_and_b32 v60, 1, v0
s_waitcnt lgkmcnt(9)
v_mfma_f32_16x16x32_bf16 v[32:35], v[196:199], v[136:139], v[32:35]
ds_read_b64_tr_b16 v[236:237], v100 offset:26624
ds_read_b64_tr_b16 v[238:239], v100 offset:28672
v_mul_u32_u24 v57, 176, v59
v_mfma_f32_16x16x32_bf16 v[176:179], v[196:199], v[140:143], v[176:179]
ds_read_b64_tr_b16 v[240:241], v101 offset:26624
v_lshl_add_u32 v57, v60, 4, v57
v_mfma_f32_16x16x32_bf16 v[36:39], v[200:203], v[136:139], v[36:39]
buffer_load_dwordx4 v[128:131], v15, s[32:35], s15 offen sc1
v_add_u32 v57, s59, v57
v_mfma_f32_16x16x32_bf16 v[180:183], v[200:203], v[140:143], v[180:183]
ds_read_b64_tr_b16 v[242:243], v101 offset:28672
ds_read_b64_tr_b16 v[244:245], v102 offset:26624
v_add_u32 v59, s58, v59
v_mfma_f32_16x16x32_bf16 v[40:43], v[204:207], v[136:139], v[40:43]
ds_read_b64_tr_b16 v[246:247], v102 offset:28672
v_mul_u32_u24 v59, 1280, v59
v_mfma_f32_16x16x32_bf16 v[184:187], v[204:207], v[140:143], v[184:187]
buffer_load_dwordx4 v[132:135], v14, s[32:35], s15 offen sc1
v_lshl_add_u32 v59, v60, 4, v59
v_mfma_f32_16x16x32_bf16 v[44:47], v[208:211], v[136:139], v[44:47]
ds_read_b64_tr_b16 v[248:249], v103 offset:26624
ds_read_b64_tr_b16 v[250:251], v103 offset:28672
s_lshl_b32 s60, s49, 5
v_mfma_f32_16x16x32_bf16 v[188:191], v[208:211], v[140:143], v[188:191]
ds_read_b128 v[252:255], v109 offset:34816
s_add_u32 s60, s60, 1024
v_mfma_f32_16x16x32_bf16 v[48:51], v[212:215], v[136:139], v[48:51]
v_add_u32 v59, s60, v59
v_mfma_f32_16x16x32_bf16 v[192:195], v[212:215], v[140:143], v[192:195]
v_lshrrev_b32 v60, 5, v0
s_barrier
s_waitcnt lgkmcnt(9) vmcnt(8)
v_mfma_f32_16x16x32_bf16 v[32:35], v[216:219], v[144:147], v[32:35]
ds_read_b64_tr_b16 v[196:197], v96 offset:61440
ds_read_b64_tr_b16 v[198:199], v96 offset:63488
v_lshl_add_u32 v59, v60, 24, v59
v_mfma_f32_16x16x32_bf16 v[176:179], v[216:219], v[148:151], v[176:179]
ds_read_b64_tr_b16 v[200:201], v97 offset:61440
s_mov_b32 s60, 10240
v_mfma_f32_16x16x32_bf16 v[36:39], v[220:223], v[144:147], v[36:39]
buffer_load_dwordx4 v[136:139], v15, s[32:35], s16 offen sc1
v_mfma_f32_16x16x32_bf16 v[180:183], v[220:223], v[148:151], v[180:183]
ds_read_b64_tr_b16 v[202:203], v97 offset:63488
ds_read_b64_tr_b16 v[204:205], v98 offset:61440
v_mfma_f32_16x16x32_bf16 v[40:43], v[224:227], v[144:147], v[40:43]
ds_read_b64_tr_b16 v[206:207], v98 offset:63488
v_mfma_f32_16x16x32_bf16 v[184:187], v[224:227], v[148:151], v[184:187]
buffer_load_dwordx4 v[140:143], v14, s[32:35], s16 offen sc1
v_mfma_f32_16x16x32_bf16 v[44:47], v[228:231], v[144:147], v[44:47]
ds_read_b64_tr_b16 v[208:209], v99 offset:61440
ds_read_b64_tr_b16 v[210:211], v99 offset:63488
v_mfma_f32_16x16x32_bf16 v[188:191], v[228:231], v[148:151], v[188:191]
ds_read_b128 v[212:215], v109 offset:4096
v_mfma_f32_16x16x32_bf16 v[48:51], v[232:235], v[144:147], v[48:51]
s_load_dwordx8 s[80:87], s[88:89], 512 glc
v_mfma_f32_16x16x32_bf16 v[192:195], v[232:235], v[148:151], v[192:195]
s_waitcnt lgkmcnt(9) vmcnt(8)
v_mfma_f32_16x16x32_bf16 v[32:35], v[236:239], v[152:155], v[32:35]
ds_read_b64_tr_b16 v[216:217], v96 offset:51200
ds_read_b64_tr_b16 v[218:219], v96 offset:53248
v_mfma_f32_16x16x32_bf16 v[176:179], v[236:239], v[156:159], v[176:179]
ds_read_b64_tr_b16 v[220:221], v97 offset:51200
v_mfma_f32_16x16x32_bf16 v[36:39], v[240:243], v[152:155], v[36:39]
buffer_load_dwordx4 v[144:147], v15, s[32:35], s17 offen sc1
v_mfma_f32_16x16x32_bf16 v[180:183], v[240:243], v[156:159], v[180:183]
ds_read_b64_tr_b16 v[222:223], v97 offset:53248
ds_read_b64_tr_b16 v[224:225], v98 offset:51200
v_mfma_f32_16x16x32_bf16 v[40:43], v[244:247], v[152:155], v[40:43]
ds_read_b64_tr_b16 v[226:227], v98 offset:53248
v_mfma_f32_16x16x32_bf16 v[184:187], v[244:247], v[156:159], v[184:187]
buffer_load_dwordx4 v[148:151], v14, s[32:35], s17 offen sc1
v_mfma_f32_16x16x32_bf16 v[44:47], v[248:251], v[152:155], v[44:47]
ds_read_b64_tr_b16 v[228:229], v99 offset:51200
ds_read_b64_tr_b16 v[230:231], v99 offset:53248
v_mfma_f32_16x16x32_bf16 v[188:191], v[248:251], v[156:159], v[188:191]
ds_read_b128 v[232:235], v108 offset:59392
v_mfma_f32_16x16x32_bf16 v[48:51], v[252:255], v[152:155], v[48:51]
v_mfma_f32_16x16x32_bf16 v[192:195], v[252:255], v[156:159], v[192:195]
s_barrier
s_waitcnt lgkmcnt(9) vmcnt(8)
v_mfma_f32_16x16x32_bf16 v[32:35], v[196:199], v[112:115], v[32:35]
ds_read_b64_tr_b16 v[236:237], v96 offset:40960
ds_read_b64_tr_b16 v[238:239], v96 offset:43008
v_mfma_f32_16x16x32_bf16 v[176:179], v[196:199], v[116:119], v[176:179]
ds_read_b64_tr_b16 v[240:241], v97 offset:40960
v_mfma_f32_16x16x32_bf16 v[36:39], v[200:203], v[112:115], v[36:39]
buffer_load_dwordx4 v[152:155], v15, s[32:35], s18 offen sc1
v_mfma_f32_16x16x32_bf16 v[180:183], v[200:203], v[116:119], v[180:183]
ds_read_b64_tr_b16 v[242:243], v97 offset:43008
ds_read_b64_tr_b16 v[244:245], v98 offset:40960
v_mfma_f32_16x16x32_bf16 v[40:43], v[204:207], v[112:115], v[40:43]
ds_read_b64_tr_b16 v[246:247], v98 offset:43008
v_mfma_f32_16x16x32_bf16 v[184:187], v[204:207], v[116:119], v[184:187]
buffer_load_dwordx4 v[156:159], v14, s[32:35], s18 offen sc1
v_mfma_f32_16x16x32_bf16 v[44:47], v[208:211], v[112:115], v[44:47]
ds_read_b64_tr_b16 v[248:249], v99 offset:40960
ds_read_b64_tr_b16 v[250:251], v99 offset:43008
v_mfma_f32_16x16x32_bf16 v[188:191], v[208:211], v[116:119], v[188:191]
ds_read_b128 v[252:255], v108 offset:49152
v_mfma_f32_16x16x32_bf16 v[48:51], v[212:215], v[112:115], v[48:51]
v_mfma_f32_16x16x32_bf16 v[192:195], v[212:215], v[116:119], v[192:195]
s_waitcnt lgkmcnt(9) vmcnt(8)
v_mfma_f32_16x16x32_bf16 v[32:35], v[216:219], v[120:123], v[32:35]
ds_read_b64_tr_b16 v[196:197], v96 offset:30720
ds_read_b64_tr_b16 v[198:199], v96 offset:32768
v_mfma_f32_16x16x32_bf16 v[176:179], v[216:219], v[124:127], v[176:179]
ds_read_b64_tr_b16 v[200:201], v97 offset:30720
v_mfma_f32_16x16x32_bf16 v[36:39], v[220:223], v[120:123], v[36:39]
buffer_load_dwordx4 v[112:115], v15, s[32:35], s19 offen sc1
v_mfma_f32_16x16x32_bf16 v[180:183], v[220:223], v[124:127], v[180:183]
ds_read_b64_tr_b16 v[202:203], v97 offset:32768
ds_read_b64_tr_b16 v[204:205], v98 offset:30720
v_mfma_f32_16x16x32_bf16 v[40:43], v[224:227], v[120:123], v[40:43]
ds_read_b64_tr_b16 v[206:207], v98 offset:32768
v_mfma_f32_16x16x32_bf16 v[184:187], v[224:227], v[124:127], v[184:187]
buffer_load_dwordx4 v[116:119], v14, s[32:35], s19 offen sc1
v_mfma_f32_16x16x32_bf16 v[44:47], v[228:231], v[120:123], v[44:47]
ds_read_b64_tr_b16 v[208:209], v99 offset:30720
ds_read_b64_tr_b16 v[210:211], v99 offset:32768
v_mfma_f32_16x16x32_bf16 v[188:191], v[228:231], v[124:127], v[188:191]
ds_read_b128 v[212:215], v108 offset:38912
v_mfma_f32_16x16x32_bf16 v[48:51], v[232:235], v[120:123], v[48:51]
v_mfma_f32_16x16x32_bf16 v[192:195], v[232:235], v[124:127], v[192:195]
s_barrier
s_waitcnt lgkmcnt(9) vmcnt(8)
v_mfma_f32_16x16x32_bf16 v[32:35], v[236:239], v[128:131], v[32:35]
ds_read_b64_tr_b16 v[216:217], v96 offset:20480
ds_read_b64_tr_b16 v[218:219], v96 offset:22528
v_mfma_f32_16x16x32_bf16 v[176:179], v[236:239], v[132:135], v[176:179]
ds_read_b64_tr_b16 v[220:221], v97 offset:20480
v_mfma_f32_16x16x32_bf16 v[36:39], v[240:243], v[128:131], v[36:39]
buffer_load_dwordx4 v[120:123], v15, s[32:35], s20 offen sc1
v_mfma_f32_16x16x32_bf16 v[180:183], v[240:243], v[132:135], v[180:183]
ds_read_b64_tr_b16 v[222:223], v97 offset:22528
ds_read_b64_tr_b16 v[224:225], v98 offset:20480
v_mfma_f32_16x16x32_bf16 v[40:43], v[244:247], v[128:131], v[40:43]
ds_read_b64_tr_b16 v[226:227], v98 offset:22528
v_mfma_f32_16x16x32_bf16 v[184:187], v[244:247], v[132:135], v[184:187]
buffer_load_dwordx4 v[124:127], v14, s[32:35], s20 offen sc1
v_mfma_f32_16x16x32_bf16 v[44:47], v[248:251], v[128:131], v[44:47]
ds_read_b64_tr_b16 v[228:229], v99 offset:20480
ds_read_b64_tr_b16 v[230:231], v99 offset:22528
v_mfma_f32_16x16x32_bf16 v[188:191], v[248:251], v[132:135], v[188:191]
ds_read_b128 v[232:235], v108 offset:28672
v_mfma_f32_16x16x32_bf16 v[48:51], v[252:255], v[128:131], v[48:51]
v_mfma_f32_16x16x32_bf16 v[192:195], v[252:255], v[132:135], v[192:195]
s_waitcnt lgkmcnt(0)
s_xor_b64 s[80:81], s[80:81], s[78:79]
s_xor_b64 s[82:83], s[82:83], s[78:79]
s_xor_b64 s[84:85], s[84:85], s[78:79]
s_xor_b64 s[86:87], s[86:87], s[78:79]
s_or_b64 s[80:81], s[80:81], s[82:83]
s_or_b64 s[84:85], s[84:85], s[86:87]
s_or_b64 s[80:81], s[80:81], s[84:85]
s_cbranch_scc1 L_poll2
L_pollok2:
s_waitcnt lgkmcnt(9) vmcnt(8)
v_mfma_f32_16x16x32_bf16 v[32:35], v[196:199], v[136:139], v[32:35]
ds_read_b64_tr_b16 v[236:237], v96 offset:10240
ds_read_b64_tr_b16 v[238:239], v96 offset:12288
v_mfma_f32_16x16x32_bf16 v[176:179], v[196:199], v[140:143], v[176:179]
ds_read_b64_tr_b16 v[240:241], v97 offset:10240
v_mfma_f32_16x16x32_bf16 v[36:39], v[200:203], v[136:139], v[36:39]
buffer_load_dwordx4 v[128:131], v15, s[32:35], s21 offen sc1
v_mfma_f32_16x16x32_bf16 v[180:183], v[200:203], v[140:143], v[180:183]
ds_read_b64_tr_b16 v[242:243], v97 offset:12288
ds_read_b64_tr_b16 v[244:245], v98 offset:10240
v_mfma_f32_16x16x32_bf16 v[40:43], v[204:207], v[136:139], v[40:43]
ds_read_b64_tr_b16 v[246:247], v98 offset:12288
v_mfma_f32_16x16x32_bf16 v[184:187], v[204:207], v[140:143], v[184:187]
buffer_load_dwordx4 v[132:135], v14, s[32:35], s21 offen sc1
v_mfma_f32_16x16x32_bf16 v[44:47], v[208:211], v[136:139], v[44:47]
ds_read_b64_tr_b16 v[248:249], v99 offset:10240
ds_read_b64_tr_b16 v[250:251], v99 offset:12288
v_mfma_f32_16x16x32_bf16 v[188:191], v[208:211], v[140:143], v[188:191]
ds_read_b128 v[252:255], v108 offset:18432
v_mfma_f32_16x16x32_bf16 v[48:51], v[212:215], v[136:139], v[48:51]
v_mfma_f32_16x16x32_bf16 v[192:195], v[212:215], v[140:143], v[192:195]
s_barrier
s_waitcnt lgkmcnt(9) vmcnt(8)
v_mfma_f32_16x16x32_bf16 v[32:35], v[216:219], v[144:147], v[32:35]
ds_read_b64_tr_b16 v[196:197], v104 offset:22528
ds_read_b64_tr_b16 v[198:199], v104 offset:24576
v_mfma_f32_16x16x32_bf16 v[176:179], v[216:219], v[148:151], v[176:179]
ds_read_b64_tr_b16 v[200:201], v105 offset:22528
v_mfma_f32_16x16x32_bf16 v[36:39], v[220:223], v[144:147], v[36:39]
buffer_load_dwordx4 v[136:139], v15, s[32:35], s22 offen sc1
v_mfma_f32_16x16x32_bf16 v[180:183], v[220:223], v[148:151], v[180:183]
ds_read_b64_tr_b16 v[202:203], v105 offset:24576
ds_read_b64_tr_b16 v[204:205], v106 offset:22528
v_mfma_f32_16x16x32_bf16 v[40:43], v[224:227], v[144:147], v[40:43]
ds_read_b64_tr_b16 v[206:207], v106 offset:24576
v_mfma_f32_16x16x32_bf16 v[184:187], v[224:227], v[148:151], v[184:187]
buffer_load_dwordx4 v[140:143], v14, s[32:35], s22 offen sc1
v_mfma_f32_16x16x32_bf16 v[44:47], v[228:231], v[144:147], v[44:47]
ds_read_b64_tr_b16 v[208:209], v107 offset:22528
ds_read_b64_tr_b16 v[210:211], v107 offset:24576
v_mfma_f32_16x16x32_bf16 v[188:191], v[228:231], v[148:151], v[188:191]
ds_read_b128 v[212:215], v110 offset:30720
v_mfma_f32_16x16x32_bf16 v[48:51], v[232:235], v[144:147], v[48:51]
v_mfma_f32_16x16x32_bf16 v[192:195], v[232:235], v[148:151], v[192:195]
s_waitcnt lgkmcnt(9) vmcnt(8)
v_mfma_f32_16x16x32_bf16 v[32:35], v[236:239], v[152:155], v[32:35]
ds_read_b64_tr_b16 v[216:217], v104 offset:12288
ds_read_b64_tr_b16 v[218:219], v104 offset:14336
v_mfma_f32_16x16x32_bf16 v[176:179], v[236:239], v[156:159], v[176:179]
ds_read_b64_tr_b16 v[220:221], v105 offset:12288
v_mfma_f32_16x16x32_bf16 v[36:39], v[240:243], v[152:155], v[36:39]
buffer_load_dwordx4 v[144:147], v15, s[32:35], s23 offen sc1
v_mfma_f32_16x16x32_bf16 v[180:183], v[240:243], v[156:159], v[180:183]
ds_read_b64_tr_b16 v[222:223], v105 offset:14336
ds_read_b64_tr_b16 v[224:225], v106 offset:12288
v_mfma_f32_16x16x32_bf16 v[40:43], v[244:247], v[152:155], v[40:43]
ds_read_b64_tr_b16 v[226:227], v106 offset:14336
v_mfma_f32_16x16x32_bf16 v[184:187], v[244:247], v[156:159], v[184:187]
buffer_load_dwordx4 v[148:151], v14, s[32:35], s23 offen sc1
v_mfma_f32_16x16x32_bf16 v[44:47], v[248:251], v[152:155], v[44:47]
ds_read_b64_tr_b16 v[228:229], v107 offset:12288
ds_read_b64_tr_b16 v[230:231], v107 offset:14336
v_mfma_f32_16x16x32_bf16 v[188:191], v[248:251], v[156:159], v[188:191]
ds_read_b128 v[232:235], v110 offset:20480
v_mfma_f32_16x16x32_bf16 v[48:51], v[252:255], v[152:155], v[48:51]
v_mfma_f32_16x16x32_bf16 v[192:195], v[252:255], v[156:159], v[192:195]
s_barrier
s_waitcnt lgkmcnt(9) vmcnt(8)
v_mfma_f32_16x16x32_bf16 v[32:35], v[196:199], v[112:115], v[32:35]
ds_read_b64_tr_b16 v[236:237], v104 offset:2048
ds_read_b64_tr_b16 v[238:239], v104 offset:4096
v_mfma_f32_16x16x32_bf16 v[176:179], v[196:199], v[116:119], v[176:179]
ds_read_b64_tr_b16 v[240:241], v105 offset:2048
v_mfma_f32_16x16x32_bf16 v[36:39], v[200:203], v[112:115], v[36:39]
buffer_load_dwordx4 v[152:155], v15, s[32:35], s24 offen sc1
v_mfma_f32_16x16x32_bf16 v[180:183], v[200:203], v[116:119], v[180:183]
ds_read_b64_tr_b16 v[242:243], v105 offset:4096
ds_read_b64_tr_b16 v[244:245], v106 offset:2048
v_mfma_f32_16x16x32_bf16 v[40:43], v[204:207], v[112:115], v[40:43]
ds_read_b64_tr_b16 v[246:247], v106 offset:4096
v_mfma_f32_16x16x32_bf16 v[184:187], v[204:207], v[116:119], v[184:187]
buffer_load_dwordx4 v[156:159], v14, s[32:35], s24 offen sc1
v_mfma_f32_16x16x32_bf16 v[44:47], v[208:211], v[112:115], v[44:47]
ds_read_b64_tr_b16 v[248:249], v107 offset:2048
ds_read_b64_tr_b16 v[250:251], v107 offset:4096
v_mfma_f32_16x16x32_bf16 v[188:191], v[208:211], v[116:119], v[188:191]
ds_read_b128 v[252:255], v110 offset:10240
v_mfma_f32_16x16x32_bf16 v[48:51], v[212:215], v[112:115], v[48:51]
v_mfma_f32_16x16x32_bf16 v[192:195], v[212:215], v[116:119], v[192:195]
s_waitcnt lgkmcnt(9) vmcnt(8)
v_mfma_f32_16x16x32_bf16 v[32:35], v[216:219], v[120:123], v[32:35]
ds_read_b64_tr_b16 v[196:197], v100 offset:57344
ds_read_b64_tr_b16 v[198:199], v100 offset:59392
v_mfma_f32_16x16x32_bf16 v[176:179], v[216:219], v[124:127], v[176:179]
ds_read_b64_tr_b16 v[200:201], v101 offset:57344
v_mfma_f32_16x16x32_bf16 v[36:39], v[220:223], v[120:123], v[36:39]
buffer_load_dwordx4 v[112:115], v15, s[32:35], s25 offen sc1
v_mfma_f32_16x16x32_bf16 v[180:183], v[220:223], v[124:127], v[180:183]
ds_read_b64_tr_b16 v[202:203], v101 offset:59392
ds_read_b64_tr_b16 v[204:205], v102 offset:57344
v_mfma_f32_16x16x32_bf16 v[40:43], v[224:227], v[120:123], v[40:43]
ds_read_b64_tr_b16 v[206:207], v102 offset:59392
v_mfma_f32_16x16x32_bf16 v[184:187], v[224:227], v[124:127], v[184:187]
buffer_load_dwordx4 v[116:119], v15, s[32:35], s26 offen sc1
v_mfma_f32_16x16x32_bf16 v[44:47], v[228:231], v[120:123], v[44:47]
ds_read_b64_tr_b16 v[208:209], v103 offset:57344
ds_read_b64_tr_b16 v[210:211], v103 offset:59392
v_mfma_f32_16x16x32_bf16 v[188:191], v[228:231], v[124:127], v[188:191]
ds_read_b128 v[212:215], v110 offset:0
v_mfma_f32_16x16x32_bf16 v[48:51], v[232:235], v[120:123], v[48:51]
v_mfma_f32_16x16x32_bf16 v[192:195], v[232:235], v[124:127], v[192:195]
s_branch L_pg4
.p2align 12
L_stub4:
s_setpc_b64 s[66:67]
s_nop 0
L_pg4:
s_barrier
s_waitcnt lgkmcnt(9) vmcnt(8)
v_mfma_f32_16x16x32_bf16 v[32:35], v[236:239], v[128:131], v[32:35]
ds_read_b64_tr_b16 v[216:217], v100 offset:47104
ds_read_b64_tr_b16 v[218:219], v100 offset:49152
v_mfma_f32_16x16x32_bf16 v[176:179], v[236:239], v[132:135], v[176:179]
ds_read_b64_tr_b16 v[220:221], v101 offset:47104
v_mfma_f32_16x16x32_bf16 v[36:39], v[240:243], v[128:131], v[36:39]
buffer_load_dwordx4 v[120:123], v15, s[32:35], s27 offen sc1
v_mfma_f32_16x16x32_bf16 v[180:183], v[240:243], v[132:135], v[180:183]
ds_read_b64_tr_b16 v[222:223], v101 offset:49152
ds_read_b64_tr_b16 v[224:225], v102 offset:47104
v_mfma_f32_16x16x32_bf16 v[40:43], v[244:247], v[128:131], v[40:43]
ds_read_b64_tr_b16 v[226:227], v102 offset:49152
v_mfma_f32_16x16x32_bf16 v[184:187], v[244:247], v[132:135], v[184:187]
buffer_load_dwordx4 v[124:127], v14, s[32:35], s25 offen sc1
v_mfma_f32_16x16x32_bf16 v[44:47], v[248:251], v[128:131], v[44:47]
ds_read_b64_tr_b16 v[228:229], v103 offset:47104
ds_read_b64_tr_b16 v[230:231], v103 offset:49152
v_mfma_f32_16x16x32_bf16 v[188:191], v[248:251], v[132:135], v[188:191]
ds_read_b128 v[232:235], v109 offset:55296
v_mfma_f32_16x16x32_bf16 v[48:51], v[252:255], v[128:131], v[48:51]
v_mfma_f32_16x16x32_bf16 v[192:195], v[252:255], v[132:135], v[192:195]
s_waitcnt lgkmcnt(9) vmcnt(8)
v_mfma_f32_16x16x32_bf16 v[32:35], v[196:199], v[136:139], v[32:35]
ds_read_b64_tr_b16 v[236:237], v100 offset:36864
ds_read_b64_tr_b16 v[238:239], v100 offset:38912
v_mfma_f32_16x16x32_bf16 v[176:179], v[196:199], v[140:143], v[176:179]
ds_read_b64_tr_b16 v[240:241], v101 offset:36864
v_mfma_f32_16x16x32_bf16 v[36:39], v[200:203], v[136:139], v[36:39]
buffer_load_dwordx4 v[128:131], v14, s[32:35], s26 offen sc1
v_mfma_f32_16x16x32_bf16 v[180:183], v[200:203], v[140:143], v[180:183]
ds_read_b64_tr_b16 v[242:243], v101 offset:38912
ds_read_b64_tr_b16 v[244:245], v102 offset:36864
v_mfma_f32_16x16x32_bf16 v[40:43], v[204:207], v[136:139], v[40:43]
ds_read_b64_tr_b16 v[246:247], v102 offset:38912
v_mfma_f32_16x16x32_bf16 v[184:187], v[204:207], v[140:143], v[184:187]
buffer_load_dwordx4 v[132:135], v14, s[32:35], s27 offen sc1
v_mfma_f32_16x16x32_bf16 v[44:47], v[208:211], v[136:139], v[44:47]
ds_read_b64_tr_b16 v[248:249], v103 offset:36864
ds_read_b64_tr_b16 v[250:251], v103 offset:38912
v_mfma_f32_16x16x32_bf16 v[188:191], v[208:211], v[140:143], v[188:191]
ds_read_b128 v[252:255], v109 offset:45056
v_mfma_f32_16x16x32_bf16 v[48:51], v[212:215], v[136:139], v[48:51]
v_mfma_f32_16x16x32_bf16 v[192:195], v[212:215], v[140:143], v[192:195]
s_barrier
s_waitcnt lgkmcnt(9) vmcnt(8)
v_mfma_f32_16x16x32_bf16 v[32:35], v[216:219], v[144:147], v[32:35]
ds_read_b64_tr_b16 v[196:197], v100 offset:26624
ds_read_b64_tr_b16 v[198:199], v100 offset:28672
v_mfma_f32_16x16x32_bf16 v[176:179], v[216:219], v[148:151], v[176:179]
ds_read_b64_tr_b16 v[200:201], v101 offset:26624
v_mfma_f32_16x16x32_bf16 v[36:39], v[220:223], v[144:147], v[36:39]
v_mfma_f32_16x16x32_bf16 v[180:183], v[220:223], v[148:151], v[180:183]
ds_read_b64_tr_b16 v[202:203], v101 offset:28672
ds_read_b64_tr_b16 v[204:205], v102 offset:26624
v_mfma_f32_16x16x32_bf16 v[40:43], v[224:227], v[144:147], v[40:43]
ds_read_b64_tr_b16 v[206:207], v102 offset:28672
v_mfma_f32_16x16x32_bf16 v[184:187], v[224:227], v[148:151], v[184:187]
v_mfma_f32_16x16x32_bf16 v[44:47], v[228:231], v[144:147], v[44:47]
ds_read_b64_tr_b16 v[208:209], v103 offset:26624
ds_read_b64_tr_b16 v[210:211], v103 offset:28672
v_mfma_f32_16x16x32_bf16 v[188:191], v[228:231], v[148:151], v[188:191]
ds_read_b128 v[212:215], v109 offset:34816
v_mfma_f32_16x16x32_bf16 v[48:51], v[232:235], v[144:147], v[48:51]
v_mfma_f32_16x16x32_bf16 v[192:195], v[232:235], v[148:151], v[192:195]
s_waitcnt lgkmcnt(9) vmcnt(6)
v_mfma_f32_16x16x32_bf16 v[32:35], v[236:239], v[152:155], v[32:35]
ds_read_b64_tr_b16 v[216:217], v100 offset:16384
ds_read_b64_tr_b16 v[218:219], v100 offset:18432
v_mfma_f32_16x16x32_bf16 v[176:179], v[236:239], v[156:159], v[176:179]
ds_read_b64_tr_b16 v[220:221], v101 offset:16384
v_mfma_f32_16x16x32_bf16 v[36:39], v[240:243], v[152:155], v[36:39]
v_mfma_f32_16x16x32_bf16 v[180:183], v[240:243], v[156:159], v[180:183]
ds_read_b64_tr_b16 v[222:223], v101 offset:18432
ds_read_b64_tr_b16 v[224:225], v102 offset:16384
v_mfma_f32_16x16x32_bf16 v[40:43], v[244:247], v[152:155], v[40:43]
ds_read_b64_tr_b16 v[226:227], v102 offset:18432
v_mfma_f32_16x16x32_bf16 v[184:187], v[244:247], v[156:159], v[184:187]
v_mfma_f32_16x16x32_bf16 v[44:47], v[248:251], v[152:155], v[44:47]
ds_read_b64_tr_b16 v[228:229], v103 offset:16384
ds_read_b64_tr_b16 v[230:231], v103 offset:18432
v_mfma_f32_16x16x32_bf16 v[188:191], v[248:251], v[156:159], v[188:191]
ds_read_b128 v[232:235], v109 offset:24576
v_mfma_f32_16x16x32_bf16 v[48:51], v[252:255], v[152:155], v[48:51]
v_mfma_f32_16x16x32_bf16 v[192:195], v[252:255], v[156:159], v[192:195]
ds_read_b128 v[80:83], v109 offset:14336
s_waitcnt lgkmcnt(0) vmcnt(3)
v_mfma_f32_16x16x32_bf16 v[48:51], v[212:215], v[112:115], v[48:51]
ds_read_b64_tr_b16 v[236:237], v100 offset:6144
ds_read_b64_tr_b16 v[238:239], v100 offset:8192
v_mfma_f32_16x16x32_bf16 v[48:51], v[232:235], v[116:119], v[48:51]
ds_read_b64_tr_b16 v[240:241], v101 offset:6144
ds_read_b64_tr_b16 v[242:243], v101 offset:8192
v_mfma_f32_16x16x32_bf16 v[48:51], v[80:83], v[120:123], v[48:51]
ds_read_b64_tr_b16 v[244:245], v102 offset:6144
ds_read_b64_tr_b16 v[246:247], v102 offset:8192
v_mfma_f32_16x16x32_bf16 v[32:35], v[196:199], v[112:115], v[32:35]
ds_read_b64_tr_b16 v[248:249], v103 offset:6144
ds_read_b64_tr_b16 v[250:251], v103 offset:8192
v_mfma_f32_16x16x32_bf16 v[32:35], v[216:219], v[116:119], v[32:35]
v_mfma_f32_16x16x32_bf16 v[36:39], v[200:203], v[112:115], v[36:39]
v_mfma_f32_16x16x32_bf16 v[36:39], v[220:223], v[116:119], v[36:39]
ds_write_b128 v62, v[48:51] offset:16384
s_waitcnt lgkmcnt(1) vmcnt(0)
v_mfma_f32_16x16x32_bf16 v[32:35], v[236:239], v[120:123], v[32:35]
v_mfma_f32_16x16x32_bf16 v[36:39], v[240:243], v[120:123], v[36:39]
v_mfma_f32_16x16x32_bf16 v[192:195], v[212:215], v[124:127], v[192:195]
v_mfma_f32_16x16x32_bf16 v[192:195], v[232:235], v[128:131], v[192:195]
v_mfma_f32_16x16x32_bf16 v[192:195], v[80:83], v[132:135], v[192:195]
s_waitcnt lgkmcnt(0)
s_barrier
ds_read_b128 v[48:51], v61 offset:16384
v_mfma_f32_16x16x32_bf16 v[40:43], v[204:207], v[112:115], v[40:43]
ds_write_b128 v62, v[32:35] offset:0
v_mfma_f32_16x16x32_bf16 v[40:43], v[224:227], v[116:119], v[40:43]
v_mfma_f32_16x16x32_bf16 v[40:43], v[244:247], v[120:123], v[40:43]
ds_write_b128 v62, v[36:39] offset:4096
v_mfma_f32_16x16x32_bf16 v[44:47], v[208:211], v[112:115], v[44:47]
v_mfma_f32_16x16x32_bf16 v[44:47], v[228:231], v[116:119], v[44:47]
v_mfma_f32_16x16x32_bf16 v[44:47], v[248:251], v[120:123], v[44:47]
s_waitcnt lgkmcnt(2)
v_mfma_f32_16x16x32_bf16 v[176:179], v[196:199], v[124:127], v[176:179]
v_add_f32 v192, v192, v48
v_add_f32 v193, v193, v49
v_mfma_f32_16x16x32_bf16 v[180:183], v[200:203], v[124:127], v[180:183]
v_add_f32 v194, v194, v50
v_add_f32 v195, v195, v51
v_mfma_f32_16x16x32_bf16 v[184:187], v[204:207], v[124:127], v[184:187]
v_cvt_pk_bf16_f32 v76, v192, v193
v_cvt_pk_bf16_f32 v77, v194, v195
v_mfma_f32_16x16x32_bf16 v[188:191], v[208:211], v[124:127], v[188:191]
ds_write_b64 v55, v[76:77] offset:128
ds_read_b128 v[28:31], v57 offset:128
v_mfma_f32_16x16x32_bf16 v[176:179], v[216:219], v[128:131], v[176:179]
ds_write_b128 v62, v[40:43] offset:8192
v_mfma_f32_16x16x32_bf16 v[180:183], v[220:223], v[128:131], v[180:183]
ds_write_b128 v62, v[44:47] offset:12288
v_mfma_f32_16x16x32_bf16 v[184:187], v[224:227], v[128:131], v[184:187]
s_waitcnt lgkmcnt(2)
buffer_store_dwordx4 v[28:31], v59, s[44:47], 0 offen sc1
v_mfma_f32_16x16x32_bf16 v[188:191], v[228:231], v[128:131], v[188:191]
s_waitcnt lgkmcnt(0)
s_barrier
ds_read_b128 v[32:35], v61 offset:0
ds_read_b128 v[36:39], v61 offset:4096
ds_read_b128 v[40:43], v61 offset:8192
ds_read_b128 v[44:47], v61 offset:12288
v_mfma_f32_16x16x32_bf16 v[176:179], v[236:239], v[132:135], v[176:179]
v_mfma_f32_16x16x32_bf16 v[180:183], v[240:243], v[132:135], v[180:183]
v_mfma_f32_16x16x32_bf16 v[184:187], v[244:247], v[132:135], v[184:187]
v_mfma_f32_16x16x32_bf16 v[188:191], v[248:251], v[132:135], v[188:191]
s_waitcnt lgkmcnt(0)
s_nop 3
v_pk_add_f32 v[176:177], v[176:177], v[32:33]
v_pk_add_f32 v[178:179], v[178:179], v[34:35]
v_cvt_pk_bf16_f32 v68, v176, v177
v_cvt_pk_bf16_f32 v69, v178, v179
v_pk_add_f32 v[180:181], v[180:181], v[36:37]
v_pk_add_f32 v[182:183], v[182:183], v[38:39]
v_cvt_pk_bf16_f32 v70, v180, v181
v_cvt_pk_bf16_f32 v71, v182, v183
ds_write2_b64 v55, v[68:69], v[70:71] offset0:0 offset1:4
v_pk_add_f32 v[184:185], v[184:185], v[40:41]
v_pk_add_f32 v[186:187], v[186:187], v[42:43]
v_cvt_pk_bf16_f32 v72, v184, v185
v_cvt_pk_bf16_f32 v73, v186, v187
v_pk_add_f32 v[188:189], v[188:189], v[44:45]
v_pk_add_f32 v[190:191], v[190:191], v[46:47]
v_cvt_pk_bf16_f32 v74, v188, v189
v_cvt_pk_bf16_f32 v75, v190, v191
ds_write2_b64 v55, v[72:73], v[74:75] offset0:8 offset1:12
ds_read_b128 v[20:23], v56
ds_read_b128 v[24:27], v56 offset:1408
s_waitcnt lgkmcnt(1)
buffer_store_dwordx4 v[20:23], v58, s[44:47], 0 offen sc1
s_waitcnt lgkmcnt(0)
buffer_store_dwordx4 v[24:27], v58, s[44:47], s60 offen sc1
s_endpgm
L_f0chk:
buffer_load_dwordx2 v[8:9], v7, s[32:35], s73 offen sc1
s_waitcnt vmcnt(0)
s_sub_u32 s72, s72, 1
s_cbranch_scc1 L_f0ok
v_cmp_ne_u32 vcc, s51, v8
v_cmp_ne_u32 s[74:75], s51, v9
s_nop 1
s_or_b64 vcc, vcc, s[74:75]
s_cbranch_scc1 L_f0chk
s_branch L_f0ok
L_epu:
s_atomic_swap s51, s[84:85], 0
s_branch L_epr
L_poll0:
s_mov_b32 s52, 262144
L_pollr0:
s_sub_u32 s52, s52, 1
s_cbranch_scc1 L_pollok0
s_load_dwordx8 s[80:87], s[88:89], 0 glc
s_waitcnt lgkmcnt(0)
s_xor_b64 s[80:81], s[80:81], s[78:79]
s_xor_b64 s[82:83], s[82:83], s[78:79]
s_xor_b64 s[84:85], s[84:85], s[78:79]
s_xor_b64 s[86:87], s[86:87], s[78:79]
s_or_b64 s[80:81], s[80:81], s[82:83]
s_or_b64 s[84:85], s[84:85], s[86:87]
s_or_b64 s[80:81], s[80:81], s[84:85]
s_cbranch_scc1 L_pollr0
s_branch L_pollok0
L_poll1:
s_mov_b32 s53, 262144
L_pollr1:
s_sub_u32 s53, s53, 1
s_cbranch_scc1 L_pollok1
s_load_dwordx8 s[80:87], s[88:89], 256 glc
s_waitcnt lgkmcnt(0)
s_xor_b64 s[80:81], s[80:81], s[78:79]
s_xor_b64 s[82:83], s[82:83], s[78:79]
s_xor_b64 s[84:85], s[84:85], s[78:79]
s_xor_b64 s[86:87], s[86:87], s[78:79]
s_or_b64 s[80:81], s[80:81], s[82:83]
s_or_b64 s[84:85], s[84:85], s[86:87]
s_or_b64 s[80:81], s[80:81], s[84:85]
s_cbranch_scc1 L_pollr1
s_branch L_pollok1
L_poll2:
s_mov_b32 s54, 262144
L_pollr2:
s_sub_u32 s54, s54, 1
s_cbranch_scc1 L_pollok2
s_load_dwordx8 s[80:87], s[88:89], 512 glc
s_waitcnt lgkmcnt(0)
s_xor_b64 s[80:81], s[80:81], s[78:79]
s_xor_b64 s[82:83], s[82:83], s[78:79]
s_xor_b64 s[84:85], s[84:85], s[78:79]
s_xor_b64 s[86:87], s[86:87], s[78:79]
s_or_b64 s[80:81], s[80:81], s[82:83]
s_or_b64 s[84:85], s[84:85], s[86:87]
s_or_b64 s[80:81], s[80:81], s[84:85]
s_cbranch_scc1 L_pollr2
s_branch L_pollok2
.p2align 6
.type L_table,@object
L_table:
.long 0x12618820, 0xe4ac9ec, 0xb69c1aa, 0x2f48b968
.long 0x12618820, 0xf5911ec, 0xb69c1aa, 0x2f48b968
.long 0x12618820, 0x953c9ec, 0x1169c1aa, 0x2f48b965
.long 0x12618820, 0x8aac9ec, 0x1769c1a7, 0x2f48b905
.long 0xc360820, 0x8dac9e9, 0x1d69c147, 0x2f48ad05
.long 0xcf18820, 0x204ac989, 0xb69b547, 0x2f472d11
.long 0x24618820, 0xe4abd89, 0xb683553, 0x2f172e88
.long 0x12618820, 0xe493d95, 0xb3836ca, 0x29175d68
.long 0x12601483, 0xe1ac9ec, 0x569c1aa, 0x2f48b968
.long 0x12601483, 0x353c9ec, 0x1169c1aa, 0x2f48b962
.long 0x12601483, 0x2aac9ec, 0x1769c1a7, 0x2f48b902
.long 0xcc01483, 0x1a1ac9e9, 0x569c147, 0x2f48ad0e
.long 0xcf01483, 0x201ac989, 0x569b547, 0x2f472d11
.long 0x24601483, 0xe1abd89, 0x5683553, 0x2f172e88
.long 0x12601483, 0xe193d95, 0x53836ca, 0x29175d68
.long 0x12601483, 0xf593c2c, 0x569c1aa, 0x2f48b968
.long 0x123020e6, 0x81ac9ec, 0x569c1aa, 0x2f48b965
.long 0x123020e6, 0x2aac9ec, 0x1769c1a4, 0x2f48b8a2
.long 0x6c020e6, 0x1a1ac9e9, 0x569c144, 0x2f48acae
.long 0x1e3020e6, 0x81ac989, 0x569b550, 0x2f472e25
.long 0x243020e6, 0x81abd89, 0x5683553, 0x2f172e85
.long 0x123020e6, 0x8193d95, 0x53836ca, 0x29175d65
.long 0x123020e6, 0x9593c2c, 0x569c1aa, 0x2f48b965
.long 0x123020e6, 0x35911ec, 0xb69c1aa, 0x2f48b962
.long 0xc302d49, 0x81ac9ec, 0x569c1a7, 0x2f48b905
.long 0x6c02d49, 0x1a1ac9e6, 0x569c0e4, 0x2f48a0ae
.long 0x1e302d49, 0x81ac986, 0x569b4f0, 0x2f472225
.long 0xc302d49, 0x81abd92, 0x5683667, 0x2f175105
.long 0xc302d49, 0x8193d95, 0x53836c7, 0x29175d05
.long 0xc302d49, 0x9593c2c, 0x569c1a7, 0x2f48b905
.long 0xc302d49, 0x35911ec, 0xb69c1a7, 0x2f48b902
.long 0xc302d49, 0x353c9ec, 0x1169c1a4, 0x2f48b8a2
.long 0xc3039ac, 0x9593c29, 0x569c147, 0x2f48ad05
.long 0xc3039ac, 0x35911e9, 0xb69c147, 0x2f48ad02
.long 0xc3039ac, 0x353c9e9, 0x1169c144, 0x2f48aca2
.long 0xc3039ac, 0x2aac9e9, 0x1769c0e4, 0x2f48a0a2
.long 0xc3039ac, 0x81ac9e9, 0x569c147, 0x2f48ad05
.long 0x1e3039ac, 0x81ac926, 0x569a8f0, 0x2f45a225
.long 0xc3039ac, 0x81abd32, 0x5682a67, 0x2f15d105
.long 0xc3039ac, 0x8193ea9, 0x5385947, 0x291bad05
.long 0xc30460f, 0x3591189, 0xb69b547, 0x2f472d02
.long 0xc30460f, 0x353c989, 0x1169b544, 0x2f472ca2
.long 0xc30460f, 0x2aac989, 0x1769b4e4, 0x2f4720a2
.long 0x6c0460f, 0x1a1ac926, 0x569a8e4, 0x2f45a0ae
.long 0xc30460f, 0x81ac989, 0x569b547, 0x2f472d05
.long 0xc30460f, 0x81ab132, 0x566aa67, 0x2ee5d105
.long 0xc30460f, 0x81932a9, 0x536d947, 0x28ebad05
.long 0xc30460f, 0x9590589, 0x569b547, 0x2f472d05
.long 0xc305272, 0x353bd89, 0x11683544, 0x2f172ca2
.long 0xc305272, 0x2aabd89, 0x176834e4, 0x2f1720a2
.long 0x6c05272, 0x1a1abd26, 0x56828e4, 0x2f15a0ae
.long 0x1e305272, 0x81ab126, 0x566a8f0, 0x2ee5a225
.long 0xc305272, 0x81abd89, 0x5683547, 0x2f172d05
.long 0xc305272, 0x817b2a9, 0x506d947, 0x22ebad05
.long 0xc305272, 0x9578589, 0x5683547, 0x2f172d05
.long 0xc305272, 0x3523d89, 0xb683547, 0x2f172d02
.long 0xc305ed5, 0x2a93d89, 0x173834e4, 0x291720a2
.long 0x6c05ed5, 0x1a193d26, 0x53828e4, 0x2915a0ae
.long 0x1e305ed5, 0x8193126, 0x536a8f0, 0x28e5a225
.long 0xc305ed5, 0x817b132, 0x506aa67, 0x22e5d105
.long 0xc305ed5, 0x8193d89, 0x5383547, 0x29172d05
.long 0xc305ed5, 0x9278589, 0x5383547, 0x29172d05
.long 0xc305ed5, 0x3223d89, 0xb383547, 0x29172d02
.long 0xc305ed5, 0x2793d89, 0x11383544, 0x29172ca2
L_codeend:
.fill 2048, 4, 0xbf800000
.section .rodata,"a"
.p2align 6
.amdhsa_kernel standalone__dense_activation_gelu__prompt_kernel
  .amdhsa_next_free_vgpr 256
  .amdhsa_next_free_sgpr 100
  .amdhsa_accum_offset 256
  .amdhsa_group_segment_fixed_size 0
  .amdhsa_kernarg_size 64
  .amdhsa_user_sgpr_count 2
  .amdhsa_user_sgpr_kernarg_segment_ptr 1
  .amdhsa_system_sgpr_workgroup_id_x 1
.end_amdhsa_kernel
```
